```python
import torch

def _softmax(x, axis=-1):
    return torch.softmax(x, dim=axis)
def _gelu(x):
    return torch.nn.functional.gelu(x, approximate="tanh")
def _silu(x):
    return torch.nn.functional.silu(x)
def _sigmoid(x):
    return torch.sigmoid(x)
def _layernorm(x, axis=-1, eps=1e-5):
    m = x.mean(dim=axis, keepdim=True)
    v = x.var(dim=axis, keepdim=True, unbiased=False)
    return (x - m) / torch.sqrt(v + eps)
def _scatter_add(tgt, idx, src, axis=0):
    return tgt.clone().index_add_(axis, idx, src)
def _segment_sum(src, seg, n):
    out = torch.zeros((n,) + src.shape[1:], dtype=src.dtype)
    return out.index_add_(0, seg, src)
def _pad(x, pw):
    flat = tuple(v for pair in reversed(pw) for v in pair)
    return torch.nn.functional.pad(x, flat)

kernel_name = 'gated_mix__spectral_fnet__glu_gated_glu__prompt'

def setup_inputs():

    _w = (lambda a: (lambda t: t.to(torch.bfloat16) if t.is_floating_point() else t)(torch.as_tensor(a)))
    def _A_setup():
        B, S, D = 1, 2048, 512
        ns = torch.arange(S)[:, None] * torch.arange(S)[None, :]
        nd = torch.arange(D)[:, None] * torch.arange(D)[None, :]
        Ws_re = torch.cos(-2.0 * torch.pi * ns / S).to(float)
        Ws_im = torch.sin(-2.0 * torch.pi * ns / S).to(float)
        Wd_re = torch.cos(-2.0 * torch.pi * nd / D).to(float)
        Wd_im = torch.sin(-2.0 * torch.pi * nd / D).to(float)
        return {
            "x": _w((lambda *s: torch.randn(*s, dtype=torch.bfloat16) * 0.05)(B, S, D)),
            "dft_seq_re": _w(Ws_re),
            "dft_seq_im": _w(Ws_im),
            "dft_hid_re": _w(Wd_re),
            "dft_hid_im": _w(Wd_im),
        }
    _A_in = _A_setup()

    def _B_setup():
        B, S, D, F = 1, 2048, 512, 1792
        return {
            "x": _w((lambda *s: torch.randn(*s, dtype=torch.bfloat16) * 0.05)(B, S, D)),
            "w_gate": _w((lambda *s: torch.randn(*s, dtype=torch.bfloat16) * 1.6)(D, F)),
            "w_up": _w((lambda *s: torch.randn(*s, dtype=torch.bfloat16) * 0.8)(D, F)),
            "w_down": _w((lambda *s: torch.randn(*s, dtype=torch.bfloat16) * 0.8)(F, D)),
        }
    _B_in = _B_setup()

    return {
        "A_x": _A_in["x"],
        "A_dft_seq_re": _A_in["dft_seq_re"],
        "A_dft_seq_im": _A_in["dft_seq_im"],
        "A_dft_hid_re": _A_in["dft_hid_re"],
        "A_dft_hid_im": _A_in["dft_hid_im"],
        "B_x": _B_in["x"],
        "B_w_gate": _B_in["w_gate"],
        "B_w_up": _B_in["w_up"],
        "B_w_down": _B_in["w_down"],
        "gate_w": _w((lambda *s: torch.randn(*s, dtype=torch.bfloat16) * 0.05)(512) * 16.0),
    }

def reference(A_x, A_dft_seq_re, A_dft_seq_im, A_dft_hid_re, A_dft_hid_im, B_x, B_w_gate, B_w_up, B_w_down, gate_w):
    def _A_ref(x, dft_seq_re, dft_seq_im, dft_hid_re, dft_hid_im):
        a = torch.einsum("bsd,ed->bse", x, dft_hid_re)
        b = torch.einsum("bsd,ed->bse", x, dft_hid_im)
        y = torch.einsum("ts,bse->bte", dft_seq_re, a) - torch.einsum("ts,bse->bte", dft_seq_im, b)
        return y

    def _B_ref(x, w_gate, w_up, w_down):
        g = torch.einsum("bsd,df->bsf", x, w_gate)
        u = torch.einsum("bsd,df->bsf", x, w_up)
        h = _sigmoid(g) * u
        return torch.einsum("bsf,fd->bsd", h, w_down)

    x = A_x
    g = _sigmoid((x * gate_w).sum(-1, keepdims=True))
    a = _A_ref(x, A_dft_seq_re, A_dft_seq_im, A_dft_hid_re, A_dft_hid_im)
    b = _B_ref(x, B_w_gate, B_w_up, B_w_down)
    return g * a + (1 - g) * b
```

```asm
; @launch kernel=gated_mix__spectral_fnet__glu_gated_glu__prompt_kernel grid=(256,1,1) block=(512,1,1) lds=147456
; @launch kernel=gmix_stage2_kernel grid=(256,1,1) block=(256,1,1) lds=69632
.amdgcn_target "amdgcn-amd-amdhsa--gfx950"
.text
    .globl gated_mix__spectral_fnet__glu_gated_glu__prompt_kernel
    .p2align 8
    .type gated_mix__spectral_fnet__glu_gated_glu__prompt_kernel,@function
gated_mix__spectral_fnet__glu_gated_glu__prompt_kernel:
    s_cmp_ge_u32 s2, 256
    s_cbranch_scc1 S1_exit
    s_load_dwordx16 s[16:31], s[0:1], 0
    s_load_dwordx8 s[32:39], s[0:1], 64
    s_load_dwordx2 s[40:41], s[0:1], 96
    v_lshrrev_b32 v1, 6, v0
    v_and_b32 v250, 63, v0
    v_readfirstlane_b32 s3, v1
    s_and_b32 s4, s2, 7
    s_lshr_b32 s5, s2, 3
    s_waitcnt lgkmcnt(0)
    s_cmp_ge_u32 s5, 30
    s_cbranch_scc1 S1_aux
    s_mov_b32 s56, s40
    s_mov_b32 s57, s41
    s_mov_b32 s58, 0xb00000
    s_mov_b32 s59, 0x00020000
    s_cmp_ge_u32 s5, 16
    s_cbranch_scc1 S1_typeB
    s_lshl_b32 s66, s4, 2
    s_lshr_b32 s67, s5, 2
    s_add_u32 s66, s66, s67
    s_and_b32 s67, s5, 3
    s_lshr_b32 s75, s5, 2
    s_add_u32 s75, s75, s67
    s_and_b32 s75, s75, 3
    s_cmp_ge_u32 s66, 16
    s_cselect_b32 s68, s20, s18
    s_cselect_b32 s69, s21, s19
    s_cselect_b32 s70, 32, 0
    s_mov_b32 s44, s68
    s_mov_b32 s45, s69
    s_mov_b32 s46, 0x800000
    s_mov_b32 s47, 0x00020000
    s_mov_b32 s48, s16
    s_mov_b32 s49, s17
    s_mov_b32 s50, 0x200000
    s_mov_b32 s51, 0x00020000
    s_and_b32 s66, s66, 15
    s_lshl_b32 s60, s66, 19
    s_lshl_b32 s61, s67, 8
    s_mul_i32 s74, s66, 720896
    s_lshl_b32 s67, s67, 3
    s_add_u32 s67, s67, s70
    s_lshl_b32 s67, s67, 11
    s_add_u32 s74, s74, s67
    s_cmp_ge_u32 s3, 4
    s_cbranch_scc1 TA_loader
    s_bfe_u32 s66, s3, 0x10001
    s_and_b32 s67, s3, 1
    v_and_b32 v240, 31, v250
    v_lshrrev_b32 v241, 5, v250
    v_bfe_u32 v242, v250, 1, 3
    v_xor_b32 v241, v241, v242
    v_lshlrev_b32 v241, 4, v241
    v_lshl_add_u32 v240, v240, 7, v241
    s_lshl_b32 s68, s66, 13
    v_add_u32 v192, s68, v240
    v_xor_b32 v193, 32, v192
    v_xor_b32 v194, 64, v192
    v_xor_b32 v195, 96, v192
    v_bfe_u32 v240, v250, 2, 2
    v_lshrrev_b32 v241, 5, v250
    v_lshl_add_u32 v241, v241, 3, v240
    v_lshlrev_b32 v241, 8, v241
    v_bfe_u32 v242, v250, 4, 1
    v_lshl_add_u32 v241, v242, 5, v241
    v_and_b32 v242, 3, v250
    v_lshl_add_u32 v241, v242, 3, v241
    v_add_u32 v241, 16384, v241
    s_lshl_b32 s68, s67, 1
    s_add_u32 s69, s68, 0
    v_xor_b32 v242, s69, v240
    v_lshl_add_u32 v196, v242, 6, v241
    s_add_u32 s69, s68, 1
    v_xor_b32 v242, s69, v240
    v_lshl_add_u32 v197, v242, 6, v241
    s_mul_i32 s68, s66, 360448
    s_lshl_b32 s69, s67, 13
    s_add_u32 s68, s68, s69
    v_lshlrev_b32 v208, 4, v250
    v_add_u32 v208, s68, v208
    v_add_u32 v209, 4096, v208
    s_mov_b32 s62, 0
    v_mov_b32 v0, 0
    v_mov_b32 v1, 0
    v_mov_b32 v2, 0
    v_mov_b32 v3, 0
    v_mov_b32 v4, 0
    v_mov_b32 v5, 0
    v_mov_b32 v6, 0
    v_mov_b32 v7, 0
    v_mov_b32 v8, 0
    v_mov_b32 v9, 0
    v_mov_b32 v10, 0
    v_mov_b32 v11, 0
    v_mov_b32 v12, 0
    v_mov_b32 v13, 0
    v_mov_b32 v14, 0
    v_mov_b32 v15, 0
    v_mov_b32 v16, 0
    v_mov_b32 v17, 0
    v_mov_b32 v18, 0
    v_mov_b32 v19, 0
    v_mov_b32 v20, 0
    v_mov_b32 v21, 0
    v_mov_b32 v22, 0
    v_mov_b32 v23, 0
    v_mov_b32 v24, 0
    v_mov_b32 v25, 0
    v_mov_b32 v26, 0
    v_mov_b32 v27, 0
    v_mov_b32 v28, 0
    v_mov_b32 v29, 0
    v_mov_b32 v30, 0
    v_mov_b32 v31, 0
    v_mov_b32 v32, 0
    v_mov_b32 v33, 0
    v_mov_b32 v34, 0
    v_mov_b32 v35, 0
    v_mov_b32 v36, 0
    v_mov_b32 v37, 0
    v_mov_b32 v38, 0
    v_mov_b32 v39, 0
    v_mov_b32 v40, 0
    v_mov_b32 v41, 0
    v_mov_b32 v42, 0
    v_mov_b32 v43, 0
    v_mov_b32 v44, 0
    v_mov_b32 v45, 0
    v_mov_b32 v46, 0
    v_mov_b32 v47, 0
    v_mov_b32 v48, 0
    v_mov_b32 v49, 0
    v_mov_b32 v50, 0
    v_mov_b32 v51, 0
    v_mov_b32 v52, 0
    v_mov_b32 v53, 0
    v_mov_b32 v54, 0
    v_mov_b32 v55, 0
    v_mov_b32 v56, 0
    v_mov_b32 v57, 0
    v_mov_b32 v58, 0
    v_mov_b32 v59, 0
    v_mov_b32 v60, 0
    v_mov_b32 v61, 0
    v_mov_b32 v62, 0
    v_mov_b32 v63, 0
    v_add_u32 v224, s62, v192
    v_add_u32 v225, s62, v193
    v_add_u32 v226, s62, v194
    v_add_u32 v227, s62, v195
    v_add_u32 v228, s62, v196
    v_add_u32 v229, s62, v197
    s_barrier
    ds_read_b128 v[128:131], v224 offset:0
    ds_read_b128 v[132:135], v224 offset:4096
    ds_read_b64_tr_b16 v[136:137], v228 offset:0
    ds_read_b64_tr_b16 v[138:139], v228 offset:1024
    ds_read_b64_tr_b16 v[140:141], v229 offset:0
    ds_read_b64_tr_b16 v[142:143], v229 offset:1024
    ds_read_b128 v[144:147], v225 offset:0
    ds_read_b128 v[148:151], v225 offset:4096
    ds_read_b64_tr_b16 v[152:153], v228 offset:4096
    ds_read_b64_tr_b16 v[154:155], v228 offset:5120
    ds_read_b64_tr_b16 v[156:157], v229 offset:4096
    ds_read_b64_tr_b16 v[158:159], v229 offset:5120
    s_mov_b32 s63, 16
TA_cl_1:
    s_add_u32 s62, s62, 32768
    s_cmp_eq_u32 s62, 131072
    s_cselect_b32 s62, 0, s62
    s_waitcnt lgkmcnt(6)
    v_mfma_f32_32x32x16_bf16 v[0:15], v[136:139], v[128:131], v[0:15]
    ds_read_b128 v[160:163], v226 offset:0
    ds_read_b128 v[164:167], v226 offset:4096
    ds_read_b64_tr_b16 v[168:169], v228 offset:8192
    v_mfma_f32_32x32x16_bf16 v[16:31], v[136:139], v[132:135], v[16:31]
    ds_read_b64_tr_b16 v[170:171], v228 offset:9216
    ds_read_b64_tr_b16 v[172:173], v229 offset:8192
    ds_read_b64_tr_b16 v[174:175], v229 offset:9216
    v_mfma_f32_32x32x16_bf16 v[32:47], v[140:143], v[128:131], v[32:47]
    v_add_u32 v230, s62, v192
    v_add_u32 v231, s62, v193
    v_add_u32 v232, s62, v194
    v_mfma_f32_32x32x16_bf16 v[48:63], v[140:143], v[132:135], v[48:63]
    v_add_u32 v233, s62, v195
    v_add_u32 v234, s62, v196
    v_add_u32 v235, s62, v197
    s_waitcnt lgkmcnt(6)
    v_mfma_f32_32x32x16_bf16 v[0:15], v[152:155], v[144:147], v[0:15]
    ds_read_b128 v[176:179], v227 offset:0
    ds_read_b128 v[180:183], v227 offset:4096
    v_mfma_f32_32x32x16_bf16 v[16:31], v[152:155], v[148:151], v[16:31]
    ds_read_b64_tr_b16 v[184:185], v228 offset:12288
    ds_read_b64_tr_b16 v[186:187], v228 offset:13312
    v_mfma_f32_32x32x16_bf16 v[32:47], v[156:159], v[144:147], v[32:47]
    ds_read_b64_tr_b16 v[188:189], v229 offset:12288
    ds_read_b64_tr_b16 v[190:191], v229 offset:13312
    v_mfma_f32_32x32x16_bf16 v[48:63], v[156:159], v[148:151], v[48:63]
    s_waitcnt lgkmcnt(0)
    s_barrier
    v_mfma_f32_32x32x16_bf16 v[0:15], v[168:171], v[160:163], v[0:15]
    ds_read_b128 v[128:131], v230 offset:0
    ds_read_b128 v[132:135], v230 offset:4096
    v_mfma_f32_32x32x16_bf16 v[16:31], v[168:171], v[164:167], v[16:31]
    ds_read_b64_tr_b16 v[136:137], v234 offset:0
    ds_read_b64_tr_b16 v[138:139], v234 offset:1024
    v_mfma_f32_32x32x16_bf16 v[32:47], v[172:175], v[160:163], v[32:47]
    ds_read_b64_tr_b16 v[140:141], v235 offset:0
    ds_read_b64_tr_b16 v[142:143], v235 offset:1024
    v_mfma_f32_32x32x16_bf16 v[48:63], v[172:175], v[164:167], v[48:63]
    s_waitcnt lgkmcnt(6)
    v_mfma_f32_32x32x16_bf16 v[0:15], v[184:187], v[176:179], v[0:15]
    ds_read_b128 v[144:147], v231 offset:0
    ds_read_b128 v[148:151], v231 offset:4096
    v_mfma_f32_32x32x16_bf16 v[16:31], v[184:187], v[180:183], v[16:31]
    ds_read_b64_tr_b16 v[152:153], v234 offset:4096
    ds_read_b64_tr_b16 v[154:155], v234 offset:5120
    v_mfma_f32_32x32x16_bf16 v[32:47], v[188:191], v[176:179], v[32:47]
    ds_read_b64_tr_b16 v[156:157], v235 offset:4096
    ds_read_b64_tr_b16 v[158:159], v235 offset:5120
    v_mfma_f32_32x32x16_bf16 v[48:63], v[188:191], v[180:183], v[48:63]
    s_sub_u32 s63, s63, 1
    s_cmp_eq_u32 s63, 0
    s_cbranch_scc1 TA_cz_2
    s_add_u32 s62, s62, 32768
    s_cmp_eq_u32 s62, 131072
    s_cselect_b32 s62, 0, s62
    s_waitcnt lgkmcnt(6)
    v_mfma_f32_32x32x16_bf16 v[0:15], v[136:139], v[128:131], v[0:15]
    ds_read_b128 v[160:163], v232 offset:0
    ds_read_b128 v[164:167], v232 offset:4096
    ds_read_b64_tr_b16 v[168:169], v234 offset:8192
    v_mfma_f32_32x32x16_bf16 v[16:31], v[136:139], v[132:135], v[16:31]
    ds_read_b64_tr_b16 v[170:171], v234 offset:9216
    ds_read_b64_tr_b16 v[172:173], v235 offset:8192
    ds_read_b64_tr_b16 v[174:175], v235 offset:9216
    v_mfma_f32_32x32x16_bf16 v[32:47], v[140:143], v[128:131], v[32:47]
    v_add_u32 v224, s62, v192
    v_add_u32 v225, s62, v193
    v_add_u32 v226, s62, v194
    v_mfma_f32_32x32x16_bf16 v[48:63], v[140:143], v[132:135], v[48:63]
    v_add_u32 v227, s62, v195
    v_add_u32 v228, s62, v196
    v_add_u32 v229, s62, v197
    s_waitcnt lgkmcnt(6)
    v_mfma_f32_32x32x16_bf16 v[0:15], v[152:155], v[144:147], v[0:15]
    ds_read_b128 v[176:179], v233 offset:0
    ds_read_b128 v[180:183], v233 offset:4096
    v_mfma_f32_32x32x16_bf16 v[16:31], v[152:155], v[148:151], v[16:31]
    ds_read_b64_tr_b16 v[184:185], v234 offset:12288
    ds_read_b64_tr_b16 v[186:187], v234 offset:13312
    v_mfma_f32_32x32x16_bf16 v[32:47], v[156:159], v[144:147], v[32:47]
    ds_read_b64_tr_b16 v[188:189], v235 offset:12288
    ds_read_b64_tr_b16 v[190:191], v235 offset:13312
    v_mfma_f32_32x32x16_bf16 v[48:63], v[156:159], v[148:151], v[48:63]
    s_waitcnt lgkmcnt(0)
    s_barrier
    v_mfma_f32_32x32x16_bf16 v[0:15], v[168:171], v[160:163], v[0:15]
    ds_read_b128 v[128:131], v224 offset:0
    ds_read_b128 v[132:135], v224 offset:4096
    v_mfma_f32_32x32x16_bf16 v[16:31], v[168:171], v[164:167], v[16:31]
    ds_read_b64_tr_b16 v[136:137], v228 offset:0
    ds_read_b64_tr_b16 v[138:139], v228 offset:1024
    v_mfma_f32_32x32x16_bf16 v[32:47], v[172:175], v[160:163], v[32:47]
    ds_read_b64_tr_b16 v[140:141], v229 offset:0
    ds_read_b64_tr_b16 v[142:143], v229 offset:1024
    v_mfma_f32_32x32x16_bf16 v[48:63], v[172:175], v[164:167], v[48:63]
    s_waitcnt lgkmcnt(6)
    v_mfma_f32_32x32x16_bf16 v[0:15], v[184:187], v[176:179], v[0:15]
    ds_read_b128 v[144:147], v225 offset:0
    ds_read_b128 v[148:151], v225 offset:4096
    v_mfma_f32_32x32x16_bf16 v[16:31], v[184:187], v[180:183], v[16:31]
    ds_read_b64_tr_b16 v[152:153], v228 offset:4096
    ds_read_b64_tr_b16 v[154:155], v228 offset:5120
    v_mfma_f32_32x32x16_bf16 v[32:47], v[188:191], v[176:179], v[32:47]
    ds_read_b64_tr_b16 v[156:157], v229 offset:4096
    ds_read_b64_tr_b16 v[158:159], v229 offset:5120
    v_mfma_f32_32x32x16_bf16 v[48:63], v[188:191], v[180:183], v[48:63]
    s_branch TA_cl_1
TA_cz_2:
    s_waitcnt lgkmcnt(6)
    v_mfma_f32_32x32x16_bf16 v[0:15], v[136:139], v[128:131], v[0:15]
    ds_read_b128 v[160:163], v232 offset:0
    ds_read_b128 v[164:167], v232 offset:4096
    v_mfma_f32_32x32x16_bf16 v[16:31], v[136:139], v[132:135], v[16:31]
    ds_read_b64_tr_b16 v[168:169], v234 offset:8192
    ds_read_b64_tr_b16 v[170:171], v234 offset:9216
    v_mfma_f32_32x32x16_bf16 v[32:47], v[140:143], v[128:131], v[32:47]
    ds_read_b64_tr_b16 v[172:173], v235 offset:8192
    ds_read_b64_tr_b16 v[174:175], v235 offset:9216
    v_mfma_f32_32x32x16_bf16 v[48:63], v[140:143], v[132:135], v[48:63]
    s_waitcnt lgkmcnt(6)
    v_mfma_f32_32x32x16_bf16 v[0:15], v[152:155], v[144:147], v[0:15]
    ds_read_b128 v[176:179], v233 offset:0
    ds_read_b128 v[180:183], v233 offset:4096
    v_mfma_f32_32x32x16_bf16 v[16:31], v[152:155], v[148:151], v[16:31]
    ds_read_b64_tr_b16 v[184:185], v234 offset:12288
    ds_read_b64_tr_b16 v[186:187], v234 offset:13312
    v_mfma_f32_32x32x16_bf16 v[32:47], v[156:159], v[144:147], v[32:47]
    ds_read_b64_tr_b16 v[188:189], v235 offset:12288
    ds_read_b64_tr_b16 v[190:191], v235 offset:13312
    v_mfma_f32_32x32x16_bf16 v[48:63], v[156:159], v[148:151], v[48:63]
    s_waitcnt lgkmcnt(6)
    v_mfma_f32_32x32x16_bf16 v[0:15], v[168:171], v[160:163], v[0:15]
    v_mfma_f32_32x32x16_bf16 v[16:31], v[168:171], v[164:167], v[16:31]
    v_mfma_f32_32x32x16_bf16 v[32:47], v[172:175], v[160:163], v[32:47]
    v_mfma_f32_32x32x16_bf16 v[48:63], v[172:175], v[164:167], v[48:63]
    s_waitcnt lgkmcnt(0)
    v_mfma_f32_32x32x16_bf16 v[0:15], v[184:187], v[176:179], v[0:15]
    v_mfma_f32_32x32x16_bf16 v[16:31], v[184:187], v[180:183], v[16:31]
    v_mfma_f32_32x32x16_bf16 v[32:47], v[188:191], v[176:179], v[32:47]
    v_mfma_f32_32x32x16_bf16 v[48:63], v[188:191], v[180:183], v[48:63]
    s_nop 15
    s_nop 3
    v_cvt_pk_bf16_f32 v160, v0, v1
    v_cvt_pk_bf16_f32 v161, v2, v3
    v_cvt_pk_bf16_f32 v162, v4, v5
    v_cvt_pk_bf16_f32 v163, v6, v7
    s_nop 1
    v_permlane32_swap_b32 v160, v162
    v_permlane32_swap_b32 v161, v163
    buffer_store_dwordx4 v[160:163], v208, s[56:59], s74 offen offset:0 sc1
    v_cvt_pk_bf16_f32 v164, v8, v9
    v_cvt_pk_bf16_f32 v165, v10, v11
    v_cvt_pk_bf16_f32 v166, v12, v13
    v_cvt_pk_bf16_f32 v167, v14, v15
    s_nop 1
    v_permlane32_swap_b32 v164, v166
    v_permlane32_swap_b32 v165, v167
    buffer_store_dwordx4 v[164:167], v208, s[56:59], s74 offen offset:2048 sc1
    v_cvt_pk_bf16_f32 v168, v16, v17
    v_cvt_pk_bf16_f32 v169, v18, v19
    v_cvt_pk_bf16_f32 v170, v20, v21
    v_cvt_pk_bf16_f32 v171, v22, v23
    s_nop 1
    v_permlane32_swap_b32 v168, v170
    v_permlane32_swap_b32 v169, v171
    buffer_store_dwordx4 v[168:171], v208, s[56:59], s74 offen offset:1024 sc1
    v_cvt_pk_bf16_f32 v172, v24, v25
    v_cvt_pk_bf16_f32 v173, v26, v27
    v_cvt_pk_bf16_f32 v174, v28, v29
    v_cvt_pk_bf16_f32 v175, v30, v31
    s_nop 1
    v_permlane32_swap_b32 v172, v174
    v_permlane32_swap_b32 v173, v175
    buffer_store_dwordx4 v[172:175], v208, s[56:59], s74 offen offset:3072 sc1
    v_cvt_pk_bf16_f32 v176, v32, v33
    v_cvt_pk_bf16_f32 v177, v34, v35
    v_cvt_pk_bf16_f32 v178, v36, v37
    v_cvt_pk_bf16_f32 v179, v38, v39
    s_nop 1
    v_permlane32_swap_b32 v176, v178
    v_permlane32_swap_b32 v177, v179
    buffer_store_dwordx4 v[176:179], v209, s[56:59], s74 offen offset:0 sc1
    v_cvt_pk_bf16_f32 v180, v40, v41
    v_cvt_pk_bf16_f32 v181, v42, v43
    v_cvt_pk_bf16_f32 v182, v44, v45
    v_cvt_pk_bf16_f32 v183, v46, v47
    s_nop 1
    v_permlane32_swap_b32 v180, v182
    v_permlane32_swap_b32 v181, v183
    buffer_store_dwordx4 v[180:183], v209, s[56:59], s74 offen offset:2048 sc1
    v_cvt_pk_bf16_f32 v184, v48, v49
    v_cvt_pk_bf16_f32 v185, v50, v51
    v_cvt_pk_bf16_f32 v186, v52, v53
    v_cvt_pk_bf16_f32 v187, v54, v55
    s_nop 1
    v_permlane32_swap_b32 v184, v186
    v_permlane32_swap_b32 v185, v187
    buffer_store_dwordx4 v[184:187], v209, s[56:59], s74 offen offset:1024 sc1
    v_cvt_pk_bf16_f32 v188, v56, v57
    v_cvt_pk_bf16_f32 v189, v58, v59
    v_cvt_pk_bf16_f32 v190, v60, v61
    v_cvt_pk_bf16_f32 v191, v62, v63
    s_nop 1
    v_permlane32_swap_b32 v188, v190
    v_permlane32_swap_b32 v189, v191
    buffer_store_dwordx4 v[188:191], v209, s[56:59], s74 offen offset:3072 sc1
    s_branch TA_end
TA_loader:
    s_and_b32 s66, s3, 3
    s_lshl_b32 s64, s66, 12
    v_lshrrev_b32 v240, 3, v250
    s_lshl_b32 s67, s66, 5
    v_add_u32 v240, s67, v240
    v_and_b32 v241, 7, v250
    v_lshrrev_b32 v242, 4, v250
    v_xor_b32 v241, v241, v242
    v_add_u32 v243, 0, v240
    v_mul_u32_u24 v243, 4096, v243
    v_xor_b32 v244, 0, v241
    v_lshl_add_u32 v200, v244, 4, v243
    v_add_u32 v243, 8, v240
    v_mul_u32_u24 v243, 4096, v243
    v_xor_b32 v244, 4, v241
    v_lshl_add_u32 v201, v244, 4, v243
    v_add_u32 v243, 16, v240
    v_mul_u32_u24 v243, 4096, v243
    v_xor_b32 v244, 0, v241
    v_lshl_add_u32 v202, v244, 4, v243
    v_add_u32 v243, 24, v240
    v_mul_u32_u24 v243, 4096, v243
    v_xor_b32 v244, 4, v241
    v_lshl_add_u32 v203, v244, 4, v243
    v_lshrrev_b32 v240, 4, v250
    v_lshlrev_b32 v242, 2, v240
    v_and_b32 v241, 15, v250
    v_xor_b32 v241, v241, v242
    s_lshl_b32 s67, s66, 4
    v_add_u32 v240, s67, v240
    v_add_u32 v243, 0, v240
    v_mul_u32_u24 v243, 1024, v243
    v_lshl_add_u32 v204, v241, 4, v243
    v_add_u32 v243, 4, v240
    v_mul_u32_u24 v243, 1024, v243
    v_lshl_add_u32 v205, v241, 4, v243
    v_add_u32 v243, 8, v240
    v_mul_u32_u24 v243, 1024, v243
    v_lshl_add_u32 v206, v241, 4, v243
    v_add_u32 v243, 12, v240
    v_mul_u32_u24 v243, 1024, v243
    v_lshl_add_u32 v207, v241, 4, v243
    s_mov_b32 s65, 0
    s_mov_b32 s76, 0
    s_add_u32 s69, s76, s75
    s_and_b32 s69, s69, 3
    s_andn2_b32 s70, s76, 3
    s_or_b32 s69, s69, s70
    s_add_u32 s76, s76, 1
    s_lshl_b32 s70, s69, 7
    s_add_u32 s77, s60, s70
    s_lshl_b32 s70, s69, 16
    s_add_u32 s78, s61, s70
    s_add_u32 s68, s65, s64
    s_add_u32 m0, s68, 0
    s_nop 0
    buffer_load_dwordx4 v200, s[44:47], s77 offen lds
    s_add_u32 m0, s68, 1024
    s_nop 0
    buffer_load_dwordx4 v201, s[44:47], s77 offen lds
    s_add_u32 m0, s68, 2048
    s_nop 0
    buffer_load_dwordx4 v202, s[44:47], s77 offen lds
    s_add_u32 m0, s68, 3072
    s_nop 0
    buffer_load_dwordx4 v203, s[44:47], s77 offen lds
    s_add_u32 m0, s68, 16384
    s_nop 0
    buffer_load_dwordx4 v204, s[48:51], s78 offen lds
    s_add_u32 m0, s68, 17408
    s_nop 0
    buffer_load_dwordx4 v205, s[48:51], s78 offen lds
    s_add_u32 m0, s68, 18432
    s_nop 0
    buffer_load_dwordx4 v206, s[48:51], s78 offen lds
    s_add_u32 m0, s68, 19456
    s_nop 0
    buffer_load_dwordx4 v207, s[48:51], s78 offen lds
    s_add_u32 s65, s65, 32768
    s_cmp_eq_u32 s65, 131072
    s_cselect_b32 s65, 0, s65
    s_add_u32 s69, s76, s75
    s_and_b32 s69, s69, 3
    s_andn2_b32 s70, s76, 3
    s_or_b32 s69, s69, s70
    s_add_u32 s76, s76, 1
    s_lshl_b32 s70, s69, 7
    s_add_u32 s77, s60, s70
    s_lshl_b32 s70, s69, 16
    s_add_u32 s78, s61, s70
    s_add_u32 s68, s65, s64
    s_add_u32 m0, s68, 0
    s_nop 0
    buffer_load_dwordx4 v200, s[44:47], s77 offen lds
    s_add_u32 m0, s68, 1024
    s_nop 0
    buffer_load_dwordx4 v201, s[44:47], s77 offen lds
    s_add_u32 m0, s68, 2048
    s_nop 0
    buffer_load_dwordx4 v202, s[44:47], s77 offen lds
    s_add_u32 m0, s68, 3072
    s_nop 0
    buffer_load_dwordx4 v203, s[44:47], s77 offen lds
    s_add_u32 m0, s68, 16384
    s_nop 0
    buffer_load_dwordx4 v204, s[48:51], s78 offen lds
    s_add_u32 m0, s68, 17408
    s_nop 0
    buffer_load_dwordx4 v205, s[48:51], s78 offen lds
    s_add_u32 m0, s68, 18432
    s_nop 0
    buffer_load_dwordx4 v206, s[48:51], s78 offen lds
    s_add_u32 m0, s68, 19456
    s_nop 0
    buffer_load_dwordx4 v207, s[48:51], s78 offen lds
    s_add_u32 s65, s65, 32768
    s_cmp_eq_u32 s65, 131072
    s_cselect_b32 s65, 0, s65
    s_add_u32 s69, s76, s75
    s_and_b32 s69, s69, 3
    s_andn2_b32 s70, s76, 3
    s_or_b32 s69, s69, s70
    s_add_u32 s76, s76, 1
    s_lshl_b32 s70, s69, 7
    s_add_u32 s77, s60, s70
    s_lshl_b32 s70, s69, 16
    s_add_u32 s78, s61, s70
    s_add_u32 s68, s65, s64
    s_add_u32 m0, s68, 0
    s_nop 0
    buffer_load_dwordx4 v200, s[44:47], s77 offen lds
    s_add_u32 m0, s68, 1024
    s_nop 0
    buffer_load_dwordx4 v201, s[44:47], s77 offen lds
    s_add_u32 m0, s68, 2048
    s_nop 0
    buffer_load_dwordx4 v202, s[44:47], s77 offen lds
    s_add_u32 m0, s68, 3072
    s_nop 0
    buffer_load_dwordx4 v203, s[44:47], s77 offen lds
    s_add_u32 m0, s68, 16384
    s_nop 0
    buffer_load_dwordx4 v204, s[48:51], s78 offen lds
    s_add_u32 m0, s68, 17408
    s_nop 0
    buffer_load_dwordx4 v205, s[48:51], s78 offen lds
    s_add_u32 m0, s68, 18432
    s_nop 0
    buffer_load_dwordx4 v206, s[48:51], s78 offen lds
    s_add_u32 m0, s68, 19456
    s_nop 0
    buffer_load_dwordx4 v207, s[48:51], s78 offen lds
    s_add_u32 s65, s65, 32768
    s_cmp_eq_u32 s65, 131072
    s_cselect_b32 s65, 0, s65
    s_mov_b32 s63, 29
TA_ll:
    s_waitcnt vmcnt(16)
    s_barrier
    s_add_u32 s69, s76, s75
    s_and_b32 s69, s69, 3
    s_andn2_b32 s70, s76, 3
    s_or_b32 s69, s69, s70
    s_add_u32 s76, s76, 1
    s_lshl_b32 s70, s69, 7
    s_add_u32 s77, s60, s70
    s_lshl_b32 s70, s69, 16
    s_add_u32 s78, s61, s70
    s_add_u32 s68, s65, s64
    s_add_u32 m0, s68, 0
    s_nop 0
    buffer_load_dwordx4 v200, s[44:47], s77 offen lds
    s_add_u32 m0, s68, 1024
    s_nop 0
    buffer_load_dwordx4 v201, s[44:47], s77 offen lds
    s_add_u32 m0, s68, 2048
    s_nop 0
    buffer_load_dwordx4 v202, s[44:47], s77 offen lds
    s_add_u32 m0, s68, 3072
    s_nop 0
    buffer_load_dwordx4 v203, s[44:47], s77 offen lds
    s_add_u32 m0, s68, 16384
    s_nop 0
    buffer_load_dwordx4 v204, s[48:51], s78 offen lds
    s_add_u32 m0, s68, 17408
    s_nop 0
    buffer_load_dwordx4 v205, s[48:51], s78 offen lds
    s_add_u32 m0, s68, 18432
    s_nop 0
    buffer_load_dwordx4 v206, s[48:51], s78 offen lds
    s_add_u32 m0, s68, 19456
    s_nop 0
    buffer_load_dwordx4 v207, s[48:51], s78 offen lds
    s_add_u32 s65, s65, 32768
    s_cmp_eq_u32 s65, 131072
    s_cselect_b32 s65, 0, s65
    s_sub_u32 s63, s63, 1
    s_cmp_lg_u32 s63, 0
    s_cbranch_scc1 TA_ll
    s_waitcnt vmcnt(16)
    s_barrier
    s_waitcnt vmcnt(8)
    s_barrier
    s_waitcnt vmcnt(0)
    s_barrier
TA_end:
    s_endpgm
S1_typeB:
    s_mov_b32 s44, s16
    s_mov_b32 s45, s17
    s_mov_b32 s46, 0x200000
    s_mov_b32 s47, 0x00020000
    s_mov_b32 s48, s28
    s_mov_b32 s49, s29
    s_mov_b32 s50, 0x1c0000
    s_mov_b32 s51, 0x00020000
    s_mov_b32 s52, s30
    s_mov_b32 s53, s31
    s_mov_b32 s54, 0x1c0000
    s_mov_b32 s55, 0x00020000
    s_sub_u32 s67, s5, 16
    s_lshl_b32 s67, s67, 1
    s_mul_i32 s68, s4, 28
    s_add_u32 s68, s68, s67
    s_lshr_b32 s67, s68, 4
    s_and_b32 s68, s68, 15
    s_mov_b32 s75, 0
    s_lshl_b32 s60, s68, 17
    s_lshl_b32 s61, s67, 8
    s_mul_i32 s74, s68, 720896
    s_lshl_b32 s67, s67, 3
    s_add_u32 s67, s67, 64
    s_lshl_b32 s67, s67, 11
    s_add_u32 s74, s74, s67
    s_bfe_u32 s66, s3, 0x10001
    s_and_b32 s67, s3, 1
    v_and_b32 v240, 31, v250
    v_lshrrev_b32 v241, 5, v250
    v_bfe_u32 v242, v250, 1, 3
    v_xor_b32 v241, v241, v242
    v_lshlrev_b32 v241, 4, v241
    v_lshl_add_u32 v240, v240, 7, v241
    s_lshl_b32 s68, s66, 13
    v_add_u32 v192, s68, v240
    v_xor_b32 v193, 32, v192
    v_xor_b32 v194, 64, v192
    v_xor_b32 v195, 96, v192
    v_bfe_u32 v240, v250, 2, 2
    v_lshrrev_b32 v241, 5, v250
    v_lshl_add_u32 v241, v241, 3, v240
    v_lshlrev_b32 v241, 8, v241
    v_bfe_u32 v242, v250, 4, 1
    v_lshl_add_u32 v241, v242, 5, v241
    v_and_b32 v242, 3, v250
    v_lshl_add_u32 v241, v242, 3, v241
    v_add_u32 v241, 16384, v241
    s_lshl_b32 s68, s67, 1
    s_add_u32 s69, s68, 0
    v_xor_b32 v242, s69, v240
    v_lshl_add_u32 v196, v242, 6, v241
    s_add_u32 s69, s68, 1
    v_xor_b32 v242, s69, v240
    v_lshl_add_u32 v197, v242, 6, v241
    s_mul_i32 s68, s66, 360448
    s_lshl_b32 s69, s67, 13
    s_add_u32 s68, s68, s69
    v_lshlrev_b32 v208, 4, v250
    v_add_u32 v208, s68, v208
    v_add_u32 v209, 4096, v208
    s_and_b32 s66, s3, 3
    s_lshl_b32 s64, s66, 12
    v_lshrrev_b32 v240, 3, v250
    s_lshl_b32 s67, s66, 5
    v_add_u32 v240, s67, v240
    v_and_b32 v241, 7, v250
    v_lshrrev_b32 v242, 4, v250
    v_xor_b32 v241, v241, v242
    v_add_u32 v243, 0, v240
    v_mul_u32_u24 v243, 1024, v243
    v_xor_b32 v244, 0, v241
    v_lshl_add_u32 v200, v244, 4, v243
    v_add_u32 v243, 8, v240
    v_mul_u32_u24 v243, 1024, v243
    v_xor_b32 v244, 4, v241
    v_lshl_add_u32 v201, v244, 4, v243
    v_add_u32 v243, 16, v240
    v_mul_u32_u24 v243, 1024, v243
    v_xor_b32 v244, 0, v241
    v_lshl_add_u32 v202, v244, 4, v243
    v_add_u32 v243, 24, v240
    v_mul_u32_u24 v243, 1024, v243
    v_xor_b32 v244, 4, v241
    v_lshl_add_u32 v203, v244, 4, v243
    v_lshrrev_b32 v240, 4, v250
    v_lshlrev_b32 v242, 2, v240
    v_and_b32 v241, 15, v250
    v_xor_b32 v241, v241, v242
    s_lshl_b32 s67, s66, 4
    v_add_u32 v240, s67, v240
    v_add_u32 v243, 0, v240
    v_mul_u32_u24 v243, 3584, v243
    v_lshl_add_u32 v204, v241, 4, v243
    v_add_u32 v243, 4, v240
    v_mul_u32_u24 v243, 3584, v243
    v_lshl_add_u32 v205, v241, 4, v243
    v_add_u32 v243, 8, v240
    v_mul_u32_u24 v243, 3584, v243
    v_lshl_add_u32 v206, v241, 4, v243
    v_add_u32 v243, 12, v240
    v_mul_u32_u24 v243, 3584, v243
    v_lshl_add_u32 v207, v241, 4, v243
    s_mov_b32 s70, 0xbfb8aa3b
    s_mov_b32 s71, 0xbfb8aa3b
    s_mov_b32 s72, 1.0
    s_mov_b32 s73, 1.0
    s_cmp_ge_u32 s3, 4
    s_cbranch_scc1 TB_g1
    s_mov_b32 s62, 0
    v_mov_b32 v0, 0
    v_mov_b32 v1, 0
    v_mov_b32 v2, 0
    v_mov_b32 v3, 0
    v_mov_b32 v4, 0
    v_mov_b32 v5, 0
    v_mov_b32 v6, 0
    v_mov_b32 v7, 0
    v_mov_b32 v8, 0
    v_mov_b32 v9, 0
    v_mov_b32 v10, 0
    v_mov_b32 v11, 0
    v_mov_b32 v12, 0
    v_mov_b32 v13, 0
    v_mov_b32 v14, 0
    v_mov_b32 v15, 0
    v_mov_b32 v16, 0
    v_mov_b32 v17, 0
    v_mov_b32 v18, 0
    v_mov_b32 v19, 0
    v_mov_b32 v20, 0
    v_mov_b32 v21, 0
    v_mov_b32 v22, 0
    v_mov_b32 v23, 0
    v_mov_b32 v24, 0
    v_mov_b32 v25, 0
    v_mov_b32 v26, 0
    v_mov_b32 v27, 0
    v_mov_b32 v28, 0
    v_mov_b32 v29, 0
    v_mov_b32 v30, 0
    v_mov_b32 v31, 0
    v_mov_b32 v32, 0
    v_mov_b32 v33, 0
    v_mov_b32 v34, 0
    v_mov_b32 v35, 0
    v_mov_b32 v36, 0
    v_mov_b32 v37, 0
    v_mov_b32 v38, 0
    v_mov_b32 v39, 0
    v_mov_b32 v40, 0
    v_mov_b32 v41, 0
    v_mov_b32 v42, 0
    v_mov_b32 v43, 0
    v_mov_b32 v44, 0
    v_mov_b32 v45, 0
    v_mov_b32 v46, 0
    v_mov_b32 v47, 0
    v_mov_b32 v48, 0
    v_mov_b32 v49, 0
    v_mov_b32 v50, 0
    v_mov_b32 v51, 0
    v_mov_b32 v52, 0
    v_mov_b32 v53, 0
    v_mov_b32 v54, 0
    v_mov_b32 v55, 0
    v_mov_b32 v56, 0
    v_mov_b32 v57, 0
    v_mov_b32 v58, 0
    v_mov_b32 v59, 0
    v_mov_b32 v60, 0
    v_mov_b32 v61, 0
    v_mov_b32 v62, 0
    v_mov_b32 v63, 0
    v_mov_b32 v64, 0
    v_mov_b32 v65, 0
    v_mov_b32 v66, 0
    v_mov_b32 v67, 0
    v_mov_b32 v68, 0
    v_mov_b32 v69, 0
    v_mov_b32 v70, 0
    v_mov_b32 v71, 0
    v_mov_b32 v72, 0
    v_mov_b32 v73, 0
    v_mov_b32 v74, 0
    v_mov_b32 v75, 0
    v_mov_b32 v76, 0
    v_mov_b32 v77, 0
    v_mov_b32 v78, 0
    v_mov_b32 v79, 0
    v_mov_b32 v80, 0
    v_mov_b32 v81, 0
    v_mov_b32 v82, 0
    v_mov_b32 v83, 0
    v_mov_b32 v84, 0
    v_mov_b32 v85, 0
    v_mov_b32 v86, 0
    v_mov_b32 v87, 0
    v_mov_b32 v88, 0
    v_mov_b32 v89, 0
    v_mov_b32 v90, 0
    v_mov_b32 v91, 0
    v_mov_b32 v92, 0
    v_mov_b32 v93, 0
    v_mov_b32 v94, 0
    v_mov_b32 v95, 0
    v_mov_b32 v96, 0
    v_mov_b32 v97, 0
    v_mov_b32 v98, 0
    v_mov_b32 v99, 0
    v_mov_b32 v100, 0
    v_mov_b32 v101, 0
    v_mov_b32 v102, 0
    v_mov_b32 v103, 0
    v_mov_b32 v104, 0
    v_mov_b32 v105, 0
    v_mov_b32 v106, 0
    v_mov_b32 v107, 0
    v_mov_b32 v108, 0
    v_mov_b32 v109, 0
    v_mov_b32 v110, 0
    v_mov_b32 v111, 0
    v_mov_b32 v112, 0
    v_mov_b32 v113, 0
    v_mov_b32 v114, 0
    v_mov_b32 v115, 0
    v_mov_b32 v116, 0
    v_mov_b32 v117, 0
    v_mov_b32 v118, 0
    v_mov_b32 v119, 0
    v_mov_b32 v120, 0
    v_mov_b32 v121, 0
    v_mov_b32 v122, 0
    v_mov_b32 v123, 0
    v_mov_b32 v124, 0
    v_mov_b32 v125, 0
    v_mov_b32 v126, 0
    v_mov_b32 v127, 0
    v_add_u32 v224, s62, v192
    v_add_u32 v225, s62, v193
    v_add_u32 v226, s62, v194
    v_add_u32 v227, s62, v195
    v_add_u32 v228, s62, v196
    v_add_u32 v229, s62, v197
    s_barrier
    ds_read_b128 v[128:131], v224 offset:0
    ds_read_b128 v[132:135], v224 offset:4096
    ds_read_b64_tr_b16 v[136:137], v228 offset:0
    ds_read_b64_tr_b16 v[138:139], v228 offset:1024
    ds_read_b64_tr_b16 v[140:141], v229 offset:0
    ds_read_b64_tr_b16 v[142:143], v229 offset:1024
    ds_read_b64_tr_b16 v[144:145], v228 offset:16384
    ds_read_b64_tr_b16 v[146:147], v228 offset:17408
    ds_read_b64_tr_b16 v[148:149], v229 offset:16384
    ds_read_b64_tr_b16 v[150:151], v229 offset:17408
    s_mov_b32 s63, 4
TB_cl_3:
    s_add_u32 s62, s62, 49152
    s_cmp_eq_u32 s62, 147456
    s_cselect_b32 s62, 0, s62
    s_waitcnt lgkmcnt(0)
    v_mfma_f32_32x32x16_bf16 v[0:15], v[136:139], v[128:131], v[0:15]
    ds_read_b128 v[152:155], v225 offset:0
    ds_read_b128 v[156:159], v225 offset:4096
    v_mfma_f32_32x32x16_bf16 v[16:31], v[136:139], v[132:135], v[16:31]
    ds_read_b64_tr_b16 v[160:161], v228 offset:4096
    ds_read_b64_tr_b16 v[162:163], v228 offset:5120
    v_mfma_f32_32x32x16_bf16 v[32:47], v[140:143], v[128:131], v[32:47]
    ds_read_b64_tr_b16 v[164:165], v229 offset:4096
    ds_read_b64_tr_b16 v[166:167], v229 offset:5120
    v_mfma_f32_32x32x16_bf16 v[48:63], v[140:143], v[132:135], v[48:63]
    ds_read_b64_tr_b16 v[168:169], v228 offset:20480
    ds_read_b64_tr_b16 v[170:171], v228 offset:21504
    v_mfma_f32_32x32x16_bf16 v[64:79], v[144:147], v[128:131], v[64:79]
    ds_read_b64_tr_b16 v[172:173], v229 offset:20480
    ds_read_b64_tr_b16 v[174:175], v229 offset:21504
    v_mfma_f32_32x32x16_bf16 v[80:95], v[144:147], v[132:135], v[80:95]
    v_add_u32 v230, s62, v192
    v_add_u32 v231, s62, v193
    v_mfma_f32_32x32x16_bf16 v[96:111], v[148:151], v[128:131], v[96:111]
    v_add_u32 v232, s62, v194
    v_add_u32 v233, s62, v195
    v_mfma_f32_32x32x16_bf16 v[112:127], v[148:151], v[132:135], v[112:127]
    v_add_u32 v234, s62, v196
    v_add_u32 v235, s62, v197
    s_waitcnt lgkmcnt(0)
    v_mfma_f32_32x32x16_bf16 v[0:15], v[160:163], v[152:155], v[0:15]
    ds_read_b128 v[128:131], v226 offset:0
    ds_read_b128 v[132:135], v226 offset:4096
    v_mfma_f32_32x32x16_bf16 v[16:31], v[160:163], v[156:159], v[16:31]
    ds_read_b64_tr_b16 v[136:137], v228 offset:8192
    ds_read_b64_tr_b16 v[138:139], v228 offset:9216
    v_mfma_f32_32x32x16_bf16 v[32:47], v[164:167], v[152:155], v[32:47]
    ds_read_b64_tr_b16 v[140:141], v229 offset:8192
    ds_read_b64_tr_b16 v[142:143], v229 offset:9216
    v_mfma_f32_32x32x16_bf16 v[48:63], v[164:167], v[156:159], v[48:63]
    ds_read_b64_tr_b16 v[144:145], v228 offset:24576
    ds_read_b64_tr_b16 v[146:147], v228 offset:25600
    v_mfma_f32_32x32x16_bf16 v[64:79], v[168:171], v[152:155], v[64:79]
    ds_read_b64_tr_b16 v[148:149], v229 offset:24576
    ds_read_b64_tr_b16 v[150:151], v229 offset:25600
    v_mfma_f32_32x32x16_bf16 v[80:95], v[168:171], v[156:159], v[80:95]
    v_mfma_f32_32x32x16_bf16 v[96:111], v[172:175], v[152:155], v[96:111]
    v_mfma_f32_32x32x16_bf16 v[112:127], v[172:175], v[156:159], v[112:127]
    s_waitcnt lgkmcnt(0)
    v_mfma_f32_32x32x16_bf16 v[0:15], v[136:139], v[128:131], v[0:15]
    ds_read_b128 v[152:155], v227 offset:0
    ds_read_b128 v[156:159], v227 offset:4096
    v_mfma_f32_32x32x16_bf16 v[16:31], v[136:139], v[132:135], v[16:31]
    ds_read_b64_tr_b16 v[160:161], v228 offset:12288
    ds_read_b64_tr_b16 v[162:163], v228 offset:13312
    v_mfma_f32_32x32x16_bf16 v[32:47], v[140:143], v[128:131], v[32:47]
    ds_read_b64_tr_b16 v[164:165], v229 offset:12288
    ds_read_b64_tr_b16 v[166:167], v229 offset:13312
    v_mfma_f32_32x32x16_bf16 v[48:63], v[140:143], v[132:135], v[48:63]
    ds_read_b64_tr_b16 v[168:169], v228 offset:28672
    ds_read_b64_tr_b16 v[170:171], v228 offset:29696
    v_mfma_f32_32x32x16_bf16 v[64:79], v[144:147], v[128:131], v[64:79]
    ds_read_b64_tr_b16 v[172:173], v229 offset:28672
    ds_read_b64_tr_b16 v[174:175], v229 offset:29696
    v_mfma_f32_32x32x16_bf16 v[80:95], v[144:147], v[132:135], v[80:95]
    v_mfma_f32_32x32x16_bf16 v[96:111], v[148:151], v[128:131], v[96:111]
    v_mfma_f32_32x32x16_bf16 v[112:127], v[148:151], v[132:135], v[112:127]
    s_waitcnt lgkmcnt(0)
    s_barrier
    v_mfma_f32_32x32x16_bf16 v[0:15], v[160:163], v[152:155], v[0:15]
    ds_read_b128 v[128:131], v230 offset:0
    ds_read_b128 v[132:135], v230 offset:4096
    v_mfma_f32_32x32x16_bf16 v[16:31], v[160:163], v[156:159], v[16:31]
    ds_read_b64_tr_b16 v[136:137], v234 offset:0
    ds_read_b64_tr_b16 v[138:139], v234 offset:1024
    v_mfma_f32_32x32x16_bf16 v[32:47], v[164:167], v[152:155], v[32:47]
    ds_read_b64_tr_b16 v[140:141], v235 offset:0
    ds_read_b64_tr_b16 v[142:143], v235 offset:1024
    v_mfma_f32_32x32x16_bf16 v[48:63], v[164:167], v[156:159], v[48:63]
    ds_read_b64_tr_b16 v[144:145], v234 offset:16384
    ds_read_b64_tr_b16 v[146:147], v234 offset:17408
    v_mfma_f32_32x32x16_bf16 v[64:79], v[168:171], v[152:155], v[64:79]
    ds_read_b64_tr_b16 v[148:149], v235 offset:16384
    ds_read_b64_tr_b16 v[150:151], v235 offset:17408
    v_mfma_f32_32x32x16_bf16 v[80:95], v[168:171], v[156:159], v[80:95]
    v_mfma_f32_32x32x16_bf16 v[96:111], v[172:175], v[152:155], v[96:111]
    v_mfma_f32_32x32x16_bf16 v[112:127], v[172:175], v[156:159], v[112:127]
    s_sub_u32 s63, s63, 1
    s_cmp_eq_u32 s63, 0
    s_cbranch_scc1 TB_cz_4
    s_add_u32 s62, s62, 49152
    s_cmp_eq_u32 s62, 147456
    s_cselect_b32 s62, 0, s62
    s_waitcnt lgkmcnt(0)
    v_mfma_f32_32x32x16_bf16 v[0:15], v[136:139], v[128:131], v[0:15]
    ds_read_b128 v[152:155], v231 offset:0
    ds_read_b128 v[156:159], v231 offset:4096
    v_mfma_f32_32x32x16_bf16 v[16:31], v[136:139], v[132:135], v[16:31]
    ds_read_b64_tr_b16 v[160:161], v234 offset:4096
    ds_read_b64_tr_b16 v[162:163], v234 offset:5120
    v_mfma_f32_32x32x16_bf16 v[32:47], v[140:143], v[128:131], v[32:47]
    ds_read_b64_tr_b16 v[164:165], v235 offset:4096
    ds_read_b64_tr_b16 v[166:167], v235 offset:5120
    v_mfma_f32_32x32x16_bf16 v[48:63], v[140:143], v[132:135], v[48:63]
    ds_read_b64_tr_b16 v[168:169], v234 offset:20480
    ds_read_b64_tr_b16 v[170:171], v234 offset:21504
    v_mfma_f32_32x32x16_bf16 v[64:79], v[144:147], v[128:131], v[64:79]
    ds_read_b64_tr_b16 v[172:173], v235 offset:20480
    ds_read_b64_tr_b16 v[174:175], v235 offset:21504
    v_mfma_f32_32x32x16_bf16 v[80:95], v[144:147], v[132:135], v[80:95]
    v_add_u32 v224, s62, v192
    v_add_u32 v225, s62, v193
    v_mfma_f32_32x32x16_bf16 v[96:111], v[148:151], v[128:131], v[96:111]
    v_add_u32 v226, s62, v194
    v_add_u32 v227, s62, v195
    v_mfma_f32_32x32x16_bf16 v[112:127], v[148:151], v[132:135], v[112:127]
    v_add_u32 v228, s62, v196
    v_add_u32 v229, s62, v197
    s_waitcnt lgkmcnt(0)
    v_mfma_f32_32x32x16_bf16 v[0:15], v[160:163], v[152:155], v[0:15]
    ds_read_b128 v[128:131], v232 offset:0
    ds_read_b128 v[132:135], v232 offset:4096
    v_mfma_f32_32x32x16_bf16 v[16:31], v[160:163], v[156:159], v[16:31]
    ds_read_b64_tr_b16 v[136:137], v234 offset:8192
    ds_read_b64_tr_b16 v[138:139], v234 offset:9216
    v_mfma_f32_32x32x16_bf16 v[32:47], v[164:167], v[152:155], v[32:47]
    ds_read_b64_tr_b16 v[140:141], v235 offset:8192
    ds_read_b64_tr_b16 v[142:143], v235 offset:9216
    v_mfma_f32_32x32x16_bf16 v[48:63], v[164:167], v[156:159], v[48:63]
    ds_read_b64_tr_b16 v[144:145], v234 offset:24576
    ds_read_b64_tr_b16 v[146:147], v234 offset:25600
    v_mfma_f32_32x32x16_bf16 v[64:79], v[168:171], v[152:155], v[64:79]
    ds_read_b64_tr_b16 v[148:149], v235 offset:24576
    ds_read_b64_tr_b16 v[150:151], v235 offset:25600
    v_mfma_f32_32x32x16_bf16 v[80:95], v[168:171], v[156:159], v[80:95]
    v_mfma_f32_32x32x16_bf16 v[96:111], v[172:175], v[152:155], v[96:111]
    v_mfma_f32_32x32x16_bf16 v[112:127], v[172:175], v[156:159], v[112:127]
    s_waitcnt lgkmcnt(0)
    v_mfma_f32_32x32x16_bf16 v[0:15], v[136:139], v[128:131], v[0:15]
    ds_read_b128 v[152:155], v233 offset:0
    ds_read_b128 v[156:159], v233 offset:4096
    v_mfma_f32_32x32x16_bf16 v[16:31], v[136:139], v[132:135], v[16:31]
    ds_read_b64_tr_b16 v[160:161], v234 offset:12288
    ds_read_b64_tr_b16 v[162:163], v234 offset:13312
    v_mfma_f32_32x32x16_bf16 v[32:47], v[140:143], v[128:131], v[32:47]
    ds_read_b64_tr_b16 v[164:165], v235 offset:12288
    ds_read_b64_tr_b16 v[166:167], v235 offset:13312
    v_mfma_f32_32x32x16_bf16 v[48:63], v[140:143], v[132:135], v[48:63]
    ds_read_b64_tr_b16 v[168:169], v234 offset:28672
    ds_read_b64_tr_b16 v[170:171], v234 offset:29696
    v_mfma_f32_32x32x16_bf16 v[64:79], v[144:147], v[128:131], v[64:79]
    ds_read_b64_tr_b16 v[172:173], v235 offset:28672
    ds_read_b64_tr_b16 v[174:175], v235 offset:29696
    v_mfma_f32_32x32x16_bf16 v[80:95], v[144:147], v[132:135], v[80:95]
    v_mfma_f32_32x32x16_bf16 v[96:111], v[148:151], v[128:131], v[96:111]
    v_mfma_f32_32x32x16_bf16 v[112:127], v[148:151], v[132:135], v[112:127]
    s_waitcnt lgkmcnt(0)
    s_barrier
    v_mfma_f32_32x32x16_bf16 v[0:15], v[160:163], v[152:155], v[0:15]
    ds_read_b128 v[128:131], v224 offset:0
    ds_read_b128 v[132:135], v224 offset:4096
    v_mfma_f32_32x32x16_bf16 v[16:31], v[160:163], v[156:159], v[16:31]
    ds_read_b64_tr_b16 v[136:137], v228 offset:0
    ds_read_b64_tr_b16 v[138:139], v228 offset:1024
    v_mfma_f32_32x32x16_bf16 v[32:47], v[164:167], v[152:155], v[32:47]
    ds_read_b64_tr_b16 v[140:141], v229 offset:0
    ds_read_b64_tr_b16 v[142:143], v229 offset:1024
    v_mfma_f32_32x32x16_bf16 v[48:63], v[164:167], v[156:159], v[48:63]
    ds_read_b64_tr_b16 v[144:145], v228 offset:16384
    ds_read_b64_tr_b16 v[146:147], v228 offset:17408
    v_mfma_f32_32x32x16_bf16 v[64:79], v[168:171], v[152:155], v[64:79]
    ds_read_b64_tr_b16 v[148:149], v229 offset:16384
    ds_read_b64_tr_b16 v[150:151], v229 offset:17408
    v_mfma_f32_32x32x16_bf16 v[80:95], v[168:171], v[156:159], v[80:95]
    v_mfma_f32_32x32x16_bf16 v[96:111], v[172:175], v[152:155], v[96:111]
    v_mfma_f32_32x32x16_bf16 v[112:127], v[172:175], v[156:159], v[112:127]
    s_branch TB_cl_3
TB_cz_4:
    s_waitcnt lgkmcnt(0)
    v_mfma_f32_32x32x16_bf16 v[0:15], v[136:139], v[128:131], v[0:15]
    ds_read_b128 v[152:155], v231 offset:0
    ds_read_b128 v[156:159], v231 offset:4096
    v_mfma_f32_32x32x16_bf16 v[16:31], v[136:139], v[132:135], v[16:31]
    ds_read_b64_tr_b16 v[160:161], v234 offset:4096
    ds_read_b64_tr_b16 v[162:163], v234 offset:5120
    v_mfma_f32_32x32x16_bf16 v[32:47], v[140:143], v[128:131], v[32:47]
    ds_read_b64_tr_b16 v[164:165], v235 offset:4096
    ds_read_b64_tr_b16 v[166:167], v235 offset:5120
    v_mfma_f32_32x32x16_bf16 v[48:63], v[140:143], v[132:135], v[48:63]
    ds_read_b64_tr_b16 v[168:169], v234 offset:20480
    ds_read_b64_tr_b16 v[170:171], v234 offset:21504
    v_mfma_f32_32x32x16_bf16 v[64:79], v[144:147], v[128:131], v[64:79]
    ds_read_b64_tr_b16 v[172:173], v235 offset:20480
    ds_read_b64_tr_b16 v[174:175], v235 offset:21504
    v_mfma_f32_32x32x16_bf16 v[80:95], v[144:147], v[132:135], v[80:95]
    v_mfma_f32_32x32x16_bf16 v[96:111], v[148:151], v[128:131], v[96:111]
    v_mfma_f32_32x32x16_bf16 v[112:127], v[148:151], v[132:135], v[112:127]
    s_waitcnt lgkmcnt(0)
    v_mfma_f32_32x32x16_bf16 v[0:15], v[160:163], v[152:155], v[0:15]
    ds_read_b128 v[128:131], v232 offset:0
    ds_read_b128 v[132:135], v232 offset:4096
    v_mfma_f32_32x32x16_bf16 v[16:31], v[160:163], v[156:159], v[16:31]
    ds_read_b64_tr_b16 v[136:137], v234 offset:8192
    ds_read_b64_tr_b16 v[138:139], v234 offset:9216
    v_mfma_f32_32x32x16_bf16 v[32:47], v[164:167], v[152:155], v[32:47]
    ds_read_b64_tr_b16 v[140:141], v235 offset:8192
    ds_read_b64_tr_b16 v[142:143], v235 offset:9216
    v_mfma_f32_32x32x16_bf16 v[48:63], v[164:167], v[156:159], v[48:63]
    ds_read_b64_tr_b16 v[144:145], v234 offset:24576
    ds_read_b64_tr_b16 v[146:147], v234 offset:25600
    v_mfma_f32_32x32x16_bf16 v[64:79], v[168:171], v[152:155], v[64:79]
    ds_read_b64_tr_b16 v[148:149], v235 offset:24576
    ds_read_b64_tr_b16 v[150:151], v235 offset:25600
    v_mfma_f32_32x32x16_bf16 v[80:95], v[168:171], v[156:159], v[80:95]
    v_mfma_f32_32x32x16_bf16 v[96:111], v[172:175], v[152:155], v[96:111]
    v_mfma_f32_32x32x16_bf16 v[112:127], v[172:175], v[156:159], v[112:127]
    s_waitcnt lgkmcnt(0)
    v_mfma_f32_32x32x16_bf16 v[0:15], v[136:139], v[128:131], v[0:15]
    ds_read_b128 v[152:155], v233 offset:0
    ds_read_b128 v[156:159], v233 offset:4096
    v_mfma_f32_32x32x16_bf16 v[16:31], v[136:139], v[132:135], v[16:31]
    ds_read_b64_tr_b16 v[160:161], v234 offset:12288
    ds_read_b64_tr_b16 v[162:163], v234 offset:13312
    v_mfma_f32_32x32x16_bf16 v[32:47], v[140:143], v[128:131], v[32:47]
    ds_read_b64_tr_b16 v[164:165], v235 offset:12288
    ds_read_b64_tr_b16 v[166:167], v235 offset:13312
    v_mfma_f32_32x32x16_bf16 v[48:63], v[140:143], v[132:135], v[48:63]
    ds_read_b64_tr_b16 v[168:169], v234 offset:28672
    ds_read_b64_tr_b16 v[170:171], v234 offset:29696
    v_mfma_f32_32x32x16_bf16 v[64:79], v[144:147], v[128:131], v[64:79]
    ds_read_b64_tr_b16 v[172:173], v235 offset:28672
    ds_read_b64_tr_b16 v[174:175], v235 offset:29696
    v_mfma_f32_32x32x16_bf16 v[80:95], v[144:147], v[132:135], v[80:95]
    v_mfma_f32_32x32x16_bf16 v[96:111], v[148:151], v[128:131], v[96:111]
    v_mfma_f32_32x32x16_bf16 v[112:127], v[148:151], v[132:135], v[112:127]
    s_waitcnt lgkmcnt(0)
    v_mfma_f32_32x32x16_bf16 v[0:15], v[160:163], v[152:155], v[0:15]
    v_mfma_f32_32x32x16_bf16 v[16:31], v[160:163], v[156:159], v[16:31]
    v_mfma_f32_32x32x16_bf16 v[32:47], v[164:167], v[152:155], v[32:47]
    v_mfma_f32_32x32x16_bf16 v[48:63], v[164:167], v[156:159], v[48:63]
    v_mfma_f32_32x32x16_bf16 v[64:79], v[168:171], v[152:155], v[64:79]
    v_mfma_f32_32x32x16_bf16 v[80:95], v[168:171], v[156:159], v[80:95]
    v_mfma_f32_32x32x16_bf16 v[96:111], v[172:175], v[152:155], v[96:111]
    v_mfma_f32_32x32x16_bf16 v[112:127], v[172:175], v[156:159], v[112:127]
    s_nop 15
    s_nop 3
    s_mov_b32 s65, 49152
    s_barrier
    s_add_u32 s69, s75, 2
    s_and_b32 s69, s69, 7
    s_lshl_b32 s77, s69, 7
    s_add_u32 s77, s77, s60
    s_add_u32 s77, s77, 131072
    s_mul_i32 s78, s69, 229376
    s_add_u32 s78, s78, s61
    s_add_u32 s68, s65, s64
    s_add_u32 m0, s68, 0
    s_nop 0
    buffer_load_dwordx4 v200, s[44:47], s77 offen lds
    s_add_u32 m0, s68, 1024
    s_nop 0
    buffer_load_dwordx4 v201, s[44:47], s77 offen lds
    s_add_u32 m0, s68, 2048
    s_nop 0
    buffer_load_dwordx4 v202, s[44:47], s77 offen lds
    s_add_u32 m0, s68, 3072
    s_nop 0
    buffer_load_dwordx4 v203, s[44:47], s77 offen lds
    s_add_u32 m0, s68, 16384
    s_nop 0
    buffer_load_dwordx4 v204, s[48:51], s78 offen lds
    s_add_u32 m0, s68, 17408
    s_nop 0
    buffer_load_dwordx4 v205, s[48:51], s78 offen lds
    s_add_u32 m0, s68, 18432
    s_nop 0
    buffer_load_dwordx4 v206, s[48:51], s78 offen lds
    s_add_u32 m0, s68, 19456
    s_nop 0
    buffer_load_dwordx4 v207, s[48:51], s78 offen lds
    s_add_u32 m0, s68, 32768
    s_nop 0
    buffer_load_dwordx4 v204, s[52:55], s78 offen lds
    s_add_u32 m0, s68, 33792
    s_nop 0
    buffer_load_dwordx4 v205, s[52:55], s78 offen lds
    s_add_u32 m0, s68, 34816
    s_nop 0
    buffer_load_dwordx4 v206, s[52:55], s78 offen lds
    s_add_u32 m0, s68, 35840
    s_nop 0
    buffer_load_dwordx4 v207, s[52:55], s78 offen lds
    s_add_u32 s65, s65, 49152
    s_cmp_eq_u32 s65, 147456
    s_cselect_b32 s65, 0, s65
    v_pk_mul_f32 v[0:1], v[0:1], s[70:71]
    v_pk_mul_f32 v[2:3], v[2:3], s[70:71]
    v_pk_mul_f32 v[4:5], v[4:5], s[70:71]
    v_pk_mul_f32 v[6:7], v[6:7], s[70:71]
    v_exp_f32 v0, v0
    v_exp_f32 v1, v1
    v_exp_f32 v2, v2
    v_exp_f32 v3, v3
    v_exp_f32 v4, v4
    v_exp_f32 v5, v5
    v_exp_f32 v6, v6
    v_exp_f32 v7, v7
    v_pk_add_f32 v[0:1], v[0:1], s[72:73]
    v_pk_add_f32 v[2:3], v[2:3], s[72:73]
    v_pk_add_f32 v[4:5], v[4:5], s[72:73]
    v_pk_add_f32 v[6:7], v[6:7], s[72:73]
    v_rcp_f32 v0, v0
    v_rcp_f32 v1, v1
    v_rcp_f32 v2, v2
    v_rcp_f32 v3, v3
    v_rcp_f32 v4, v4
    v_rcp_f32 v5, v5
    v_rcp_f32 v6, v6
    v_rcp_f32 v7, v7
    v_pk_mul_f32 v[0:1], v[0:1], v[64:65]
    v_pk_mul_f32 v[2:3], v[2:3], v[66:67]
    v_pk_mul_f32 v[4:5], v[4:5], v[68:69]
    v_pk_mul_f32 v[6:7], v[6:7], v[70:71]
    v_cvt_pk_bf16_f32 v160, v0, v1
    v_cvt_pk_bf16_f32 v161, v2, v3
    v_cvt_pk_bf16_f32 v162, v4, v5
    v_cvt_pk_bf16_f32 v163, v6, v7
    s_nop 1
    v_permlane32_swap_b32 v160, v162
    v_permlane32_swap_b32 v161, v163
    buffer_store_dwordx4 v[160:163], v208, s[56:59], s74 offen offset:0 sc1
    s_barrier
    s_add_u32 s69, s75, 3
    s_and_b32 s69, s69, 7
    s_lshl_b32 s77, s69, 7
    s_add_u32 s77, s77, s60
    s_add_u32 s77, s77, 131072
    s_mul_i32 s78, s69, 229376
    s_add_u32 s78, s78, s61
    s_add_u32 s68, s65, s64
    s_add_u32 m0, s68, 0
    s_nop 0
    buffer_load_dwordx4 v200, s[44:47], s77 offen lds
    s_add_u32 m0, s68, 1024
    s_nop 0
    buffer_load_dwordx4 v201, s[44:47], s77 offen lds
    s_add_u32 m0, s68, 2048
    s_nop 0
    buffer_load_dwordx4 v202, s[44:47], s77 offen lds
    s_add_u32 m0, s68, 3072
    s_nop 0
    buffer_load_dwordx4 v203, s[44:47], s77 offen lds
    s_add_u32 m0, s68, 16384
    s_nop 0
    buffer_load_dwordx4 v204, s[48:51], s78 offen lds
    s_add_u32 m0, s68, 17408
    s_nop 0
    buffer_load_dwordx4 v205, s[48:51], s78 offen lds
    s_add_u32 m0, s68, 18432
    s_nop 0
    buffer_load_dwordx4 v206, s[48:51], s78 offen lds
    s_add_u32 m0, s68, 19456
    s_nop 0
    buffer_load_dwordx4 v207, s[48:51], s78 offen lds
    s_add_u32 m0, s68, 32768
    s_nop 0
    buffer_load_dwordx4 v204, s[52:55], s78 offen lds
    s_add_u32 m0, s68, 33792
    s_nop 0
    buffer_load_dwordx4 v205, s[52:55], s78 offen lds
    s_add_u32 m0, s68, 34816
    s_nop 0
    buffer_load_dwordx4 v206, s[52:55], s78 offen lds
    s_add_u32 m0, s68, 35840
    s_nop 0
    buffer_load_dwordx4 v207, s[52:55], s78 offen lds
    s_add_u32 s65, s65, 49152
    s_cmp_eq_u32 s65, 147456
    s_cselect_b32 s65, 0, s65
    v_pk_mul_f32 v[8:9], v[8:9], s[70:71]
    v_pk_mul_f32 v[10:11], v[10:11], s[70:71]
    v_pk_mul_f32 v[12:13], v[12:13], s[70:71]
    v_pk_mul_f32 v[14:15], v[14:15], s[70:71]
    v_exp_f32 v8, v8
    v_exp_f32 v9, v9
    v_exp_f32 v10, v10
    v_exp_f32 v11, v11
    v_exp_f32 v12, v12
    v_exp_f32 v13, v13
    v_exp_f32 v14, v14
    v_exp_f32 v15, v15
    v_pk_add_f32 v[8:9], v[8:9], s[72:73]
    v_pk_add_f32 v[10:11], v[10:11], s[72:73]
    v_pk_add_f32 v[12:13], v[12:13], s[72:73]
    v_pk_add_f32 v[14:15], v[14:15], s[72:73]
    v_rcp_f32 v8, v8
    v_rcp_f32 v9, v9
    v_rcp_f32 v10, v10
    v_rcp_f32 v11, v11
    v_rcp_f32 v12, v12
    v_rcp_f32 v13, v13
    v_rcp_f32 v14, v14
    v_rcp_f32 v15, v15
    v_pk_mul_f32 v[8:9], v[8:9], v[72:73]
    v_pk_mul_f32 v[10:11], v[10:11], v[74:75]
    v_pk_mul_f32 v[12:13], v[12:13], v[76:77]
    v_pk_mul_f32 v[14:15], v[14:15], v[78:79]
    v_cvt_pk_bf16_f32 v164, v8, v9
    v_cvt_pk_bf16_f32 v165, v10, v11
    v_cvt_pk_bf16_f32 v166, v12, v13
    v_cvt_pk_bf16_f32 v167, v14, v15
    s_nop 1
    v_permlane32_swap_b32 v164, v166
    v_permlane32_swap_b32 v165, v167
    buffer_store_dwordx4 v[164:167], v208, s[56:59], s74 offen offset:2048 sc1
    s_waitcnt vmcnt(13)
    s_barrier
    s_add_u32 s69, s75, 4
    s_and_b32 s69, s69, 7
    s_lshl_b32 s77, s69, 7
    s_add_u32 s77, s77, s60
    s_add_u32 s77, s77, 131072
    s_mul_i32 s78, s69, 229376
    s_add_u32 s78, s78, s61
    s_add_u32 s68, s65, s64
    s_add_u32 m0, s68, 0
    s_nop 0
    buffer_load_dwordx4 v200, s[44:47], s77 offen lds
    s_add_u32 m0, s68, 1024
    s_nop 0
    buffer_load_dwordx4 v201, s[44:47], s77 offen lds
    s_add_u32 m0, s68, 2048
    s_nop 0
    buffer_load_dwordx4 v202, s[44:47], s77 offen lds
    s_add_u32 m0, s68, 3072
    s_nop 0
    buffer_load_dwordx4 v203, s[44:47], s77 offen lds
    s_add_u32 m0, s68, 16384
    s_nop 0
    buffer_load_dwordx4 v204, s[48:51], s78 offen lds
    s_add_u32 m0, s68, 17408
    s_nop 0
    buffer_load_dwordx4 v205, s[48:51], s78 offen lds
    s_add_u32 m0, s68, 18432
    s_nop 0
    buffer_load_dwordx4 v206, s[48:51], s78 offen lds
    s_add_u32 m0, s68, 19456
    s_nop 0
    buffer_load_dwordx4 v207, s[48:51], s78 offen lds
    s_add_u32 m0, s68, 32768
    s_nop 0
    buffer_load_dwordx4 v204, s[52:55], s78 offen lds
    s_add_u32 m0, s68, 33792
    s_nop 0
    buffer_load_dwordx4 v205, s[52:55], s78 offen lds
    s_add_u32 m0, s68, 34816
    s_nop 0
    buffer_load_dwordx4 v206, s[52:55], s78 offen lds
    s_add_u32 m0, s68, 35840
    s_nop 0
    buffer_load_dwordx4 v207, s[52:55], s78 offen lds
    s_add_u32 s65, s65, 49152
    s_cmp_eq_u32 s65, 147456
    s_cselect_b32 s65, 0, s65
    v_pk_mul_f32 v[16:17], v[16:17], s[70:71]
    v_pk_mul_f32 v[18:19], v[18:19], s[70:71]
    v_pk_mul_f32 v[20:21], v[20:21], s[70:71]
    v_pk_mul_f32 v[22:23], v[22:23], s[70:71]
    v_exp_f32 v16, v16
    v_exp_f32 v17, v17
    v_exp_f32 v18, v18
    v_exp_f32 v19, v19
    v_exp_f32 v20, v20
    v_exp_f32 v21, v21
    v_exp_f32 v22, v22
    v_exp_f32 v23, v23
    v_pk_add_f32 v[16:17], v[16:17], s[72:73]
    v_pk_add_f32 v[18:19], v[18:19], s[72:73]
    v_pk_add_f32 v[20:21], v[20:21], s[72:73]
    v_pk_add_f32 v[22:23], v[22:23], s[72:73]
    v_rcp_f32 v16, v16
    v_rcp_f32 v17, v17
    v_rcp_f32 v18, v18
    v_rcp_f32 v19, v19
    v_rcp_f32 v20, v20
    v_rcp_f32 v21, v21
    v_rcp_f32 v22, v22
    v_rcp_f32 v23, v23
    v_pk_mul_f32 v[16:17], v[16:17], v[80:81]
    v_pk_mul_f32 v[18:19], v[18:19], v[82:83]
    v_pk_mul_f32 v[20:21], v[20:21], v[84:85]
    v_pk_mul_f32 v[22:23], v[22:23], v[86:87]
    v_cvt_pk_bf16_f32 v168, v16, v17
    v_cvt_pk_bf16_f32 v169, v18, v19
    v_cvt_pk_bf16_f32 v170, v20, v21
    v_cvt_pk_bf16_f32 v171, v22, v23
    s_nop 1
    v_permlane32_swap_b32 v168, v170
    v_permlane32_swap_b32 v169, v171
    buffer_store_dwordx4 v[168:171], v208, s[56:59], s74 offen offset:1024 sc1
    s_waitcnt vmcnt(13)
    s_barrier
    s_add_u32 s69, s75, 5
    s_and_b32 s69, s69, 7
    s_lshl_b32 s77, s69, 7
    s_add_u32 s77, s77, s60
    s_add_u32 s77, s77, 131072
    s_mul_i32 s78, s69, 229376
    s_add_u32 s78, s78, s61
    s_add_u32 s68, s65, s64
    s_add_u32 m0, s68, 0
    s_nop 0
    buffer_load_dwordx4 v200, s[44:47], s77 offen lds
    s_add_u32 m0, s68, 1024
    s_nop 0
    buffer_load_dwordx4 v201, s[44:47], s77 offen lds
    s_add_u32 m0, s68, 2048
    s_nop 0
    buffer_load_dwordx4 v202, s[44:47], s77 offen lds
    s_add_u32 m0, s68, 3072
    s_nop 0
    buffer_load_dwordx4 v203, s[44:47], s77 offen lds
    s_add_u32 m0, s68, 16384
    s_nop 0
    buffer_load_dwordx4 v204, s[48:51], s78 offen lds
    s_add_u32 m0, s68, 17408
    s_nop 0
    buffer_load_dwordx4 v205, s[48:51], s78 offen lds
    s_add_u32 m0, s68, 18432
    s_nop 0
    buffer_load_dwordx4 v206, s[48:51], s78 offen lds
    s_add_u32 m0, s68, 19456
    s_nop 0
    buffer_load_dwordx4 v207, s[48:51], s78 offen lds
    s_add_u32 m0, s68, 32768
    s_nop 0
    buffer_load_dwordx4 v204, s[52:55], s78 offen lds
    s_add_u32 m0, s68, 33792
    s_nop 0
    buffer_load_dwordx4 v205, s[52:55], s78 offen lds
    s_add_u32 m0, s68, 34816
    s_nop 0
    buffer_load_dwordx4 v206, s[52:55], s78 offen lds
    s_add_u32 m0, s68, 35840
    s_nop 0
    buffer_load_dwordx4 v207, s[52:55], s78 offen lds
    s_add_u32 s65, s65, 49152
    s_cmp_eq_u32 s65, 147456
    s_cselect_b32 s65, 0, s65
    v_pk_mul_f32 v[24:25], v[24:25], s[70:71]
    v_pk_mul_f32 v[26:27], v[26:27], s[70:71]
    v_pk_mul_f32 v[28:29], v[28:29], s[70:71]
    v_pk_mul_f32 v[30:31], v[30:31], s[70:71]
    v_exp_f32 v24, v24
    v_exp_f32 v25, v25
    v_exp_f32 v26, v26
    v_exp_f32 v27, v27
    v_exp_f32 v28, v28
    v_exp_f32 v29, v29
    v_exp_f32 v30, v30
    v_exp_f32 v31, v31
    v_pk_add_f32 v[24:25], v[24:25], s[72:73]
    v_pk_add_f32 v[26:27], v[26:27], s[72:73]
    v_pk_add_f32 v[28:29], v[28:29], s[72:73]
    v_pk_add_f32 v[30:31], v[30:31], s[72:73]
    v_rcp_f32 v24, v24
    v_rcp_f32 v25, v25
    v_rcp_f32 v26, v26
    v_rcp_f32 v27, v27
    v_rcp_f32 v28, v28
    v_rcp_f32 v29, v29
    v_rcp_f32 v30, v30
    v_rcp_f32 v31, v31
    v_pk_mul_f32 v[24:25], v[24:25], v[88:89]
    v_pk_mul_f32 v[26:27], v[26:27], v[90:91]
    v_pk_mul_f32 v[28:29], v[28:29], v[92:93]
    v_pk_mul_f32 v[30:31], v[30:31], v[94:95]
    v_cvt_pk_bf16_f32 v172, v24, v25
    v_cvt_pk_bf16_f32 v173, v26, v27
    v_cvt_pk_bf16_f32 v174, v28, v29
    v_cvt_pk_bf16_f32 v175, v30, v31
    s_nop 1
    v_permlane32_swap_b32 v172, v174
    v_permlane32_swap_b32 v173, v175
    buffer_store_dwordx4 v[172:175], v208, s[56:59], s74 offen offset:3072 sc1
    s_waitcnt vmcnt(13)
    s_barrier
    s_add_u32 s69, s75, 6
    s_and_b32 s69, s69, 7
    s_lshl_b32 s77, s69, 7
    s_add_u32 s77, s77, s60
    s_add_u32 s77, s77, 131072
    s_mul_i32 s78, s69, 229376
    s_add_u32 s78, s78, s61
    s_add_u32 s68, s65, s64
    s_add_u32 m0, s68, 0
    s_nop 0
    buffer_load_dwordx4 v200, s[44:47], s77 offen lds
    s_add_u32 m0, s68, 1024
    s_nop 0
    buffer_load_dwordx4 v201, s[44:47], s77 offen lds
    s_add_u32 m0, s68, 2048
    s_nop 0
    buffer_load_dwordx4 v202, s[44:47], s77 offen lds
    s_add_u32 m0, s68, 3072
    s_nop 0
    buffer_load_dwordx4 v203, s[44:47], s77 offen lds
    s_add_u32 m0, s68, 16384
    s_nop 0
    buffer_load_dwordx4 v204, s[48:51], s78 offen lds
    s_add_u32 m0, s68, 17408
    s_nop 0
    buffer_load_dwordx4 v205, s[48:51], s78 offen lds
    s_add_u32 m0, s68, 18432
    s_nop 0
    buffer_load_dwordx4 v206, s[48:51], s78 offen lds
    s_add_u32 m0, s68, 19456
    s_nop 0
    buffer_load_dwordx4 v207, s[48:51], s78 offen lds
    s_add_u32 m0, s68, 32768
    s_nop 0
    buffer_load_dwordx4 v204, s[52:55], s78 offen lds
    s_add_u32 m0, s68, 33792
    s_nop 0
    buffer_load_dwordx4 v205, s[52:55], s78 offen lds
    s_add_u32 m0, s68, 34816
    s_nop 0
    buffer_load_dwordx4 v206, s[52:55], s78 offen lds
    s_add_u32 m0, s68, 35840
    s_nop 0
    buffer_load_dwordx4 v207, s[52:55], s78 offen lds
    s_add_u32 s65, s65, 49152
    s_cmp_eq_u32 s65, 147456
    s_cselect_b32 s65, 0, s65
    v_pk_mul_f32 v[32:33], v[32:33], s[70:71]
    v_pk_mul_f32 v[34:35], v[34:35], s[70:71]
    v_pk_mul_f32 v[36:37], v[36:37], s[70:71]
    v_pk_mul_f32 v[38:39], v[38:39], s[70:71]
    v_exp_f32 v32, v32
    v_exp_f32 v33, v33
    v_exp_f32 v34, v34
    v_exp_f32 v35, v35
    v_exp_f32 v36, v36
    v_exp_f32 v37, v37
    v_exp_f32 v38, v38
    v_exp_f32 v39, v39
    v_pk_add_f32 v[32:33], v[32:33], s[72:73]
    v_pk_add_f32 v[34:35], v[34:35], s[72:73]
    v_pk_add_f32 v[36:37], v[36:37], s[72:73]
    v_pk_add_f32 v[38:39], v[38:39], s[72:73]
    v_rcp_f32 v32, v32
    v_rcp_f32 v33, v33
    v_rcp_f32 v34, v34
    v_rcp_f32 v35, v35
    v_rcp_f32 v36, v36
    v_rcp_f32 v37, v37
    v_rcp_f32 v38, v38
    v_rcp_f32 v39, v39
    v_pk_mul_f32 v[32:33], v[32:33], v[96:97]
    v_pk_mul_f32 v[34:35], v[34:35], v[98:99]
    v_pk_mul_f32 v[36:37], v[36:37], v[100:101]
    v_pk_mul_f32 v[38:39], v[38:39], v[102:103]
    v_cvt_pk_bf16_f32 v176, v32, v33
    v_cvt_pk_bf16_f32 v177, v34, v35
    v_cvt_pk_bf16_f32 v178, v36, v37
    v_cvt_pk_bf16_f32 v179, v38, v39
    s_nop 1
    v_permlane32_swap_b32 v176, v178
    v_permlane32_swap_b32 v177, v179
    buffer_store_dwordx4 v[176:179], v209, s[56:59], s74 offen offset:0 sc1
    s_waitcnt vmcnt(13)
    s_barrier
    s_add_u32 s69, s75, 7
    s_and_b32 s69, s69, 7
    s_lshl_b32 s77, s69, 7
    s_add_u32 s77, s77, s60
    s_add_u32 s77, s77, 131072
    s_mul_i32 s78, s69, 229376
    s_add_u32 s78, s78, s61
    s_add_u32 s68, s65, s64
    s_add_u32 m0, s68, 0
    s_nop 0
    buffer_load_dwordx4 v200, s[44:47], s77 offen lds
    s_add_u32 m0, s68, 1024
    s_nop 0
    buffer_load_dwordx4 v201, s[44:47], s77 offen lds
    s_add_u32 m0, s68, 2048
    s_nop 0
    buffer_load_dwordx4 v202, s[44:47], s77 offen lds
    s_add_u32 m0, s68, 3072
    s_nop 0
    buffer_load_dwordx4 v203, s[44:47], s77 offen lds
    s_add_u32 m0, s68, 16384
    s_nop 0
    buffer_load_dwordx4 v204, s[48:51], s78 offen lds
    s_add_u32 m0, s68, 17408
    s_nop 0
    buffer_load_dwordx4 v205, s[48:51], s78 offen lds
    s_add_u32 m0, s68, 18432
    s_nop 0
    buffer_load_dwordx4 v206, s[48:51], s78 offen lds
    s_add_u32 m0, s68, 19456
    s_nop 0
    buffer_load_dwordx4 v207, s[48:51], s78 offen lds
    s_add_u32 m0, s68, 32768
    s_nop 0
    buffer_load_dwordx4 v204, s[52:55], s78 offen lds
    s_add_u32 m0, s68, 33792
    s_nop 0
    buffer_load_dwordx4 v205, s[52:55], s78 offen lds
    s_add_u32 m0, s68, 34816
    s_nop 0
    buffer_load_dwordx4 v206, s[52:55], s78 offen lds
    s_add_u32 m0, s68, 35840
    s_nop 0
    buffer_load_dwordx4 v207, s[52:55], s78 offen lds
    s_add_u32 s65, s65, 49152
    s_cmp_eq_u32 s65, 147456
    s_cselect_b32 s65, 0, s65
    v_pk_mul_f32 v[40:41], v[40:41], s[70:71]
    v_pk_mul_f32 v[42:43], v[42:43], s[70:71]
    v_pk_mul_f32 v[44:45], v[44:45], s[70:71]
    v_pk_mul_f32 v[46:47], v[46:47], s[70:71]
    v_exp_f32 v40, v40
    v_exp_f32 v41, v41
    v_exp_f32 v42, v42
    v_exp_f32 v43, v43
    v_exp_f32 v44, v44
    v_exp_f32 v45, v45
    v_exp_f32 v46, v46
    v_exp_f32 v47, v47
    v_pk_add_f32 v[40:41], v[40:41], s[72:73]
    v_pk_add_f32 v[42:43], v[42:43], s[72:73]
    v_pk_add_f32 v[44:45], v[44:45], s[72:73]
    v_pk_add_f32 v[46:47], v[46:47], s[72:73]
    v_rcp_f32 v40, v40
    v_rcp_f32 v41, v41
    v_rcp_f32 v42, v42
    v_rcp_f32 v43, v43
    v_rcp_f32 v44, v44
    v_rcp_f32 v45, v45
    v_rcp_f32 v46, v46
    v_rcp_f32 v47, v47
    v_pk_mul_f32 v[40:41], v[40:41], v[104:105]
    v_pk_mul_f32 v[42:43], v[42:43], v[106:107]
    v_pk_mul_f32 v[44:45], v[44:45], v[108:109]
    v_pk_mul_f32 v[46:47], v[46:47], v[110:111]
    v_cvt_pk_bf16_f32 v180, v40, v41
    v_cvt_pk_bf16_f32 v181, v42, v43
    v_cvt_pk_bf16_f32 v182, v44, v45
    v_cvt_pk_bf16_f32 v183, v46, v47
    s_nop 1
    v_permlane32_swap_b32 v180, v182
    v_permlane32_swap_b32 v181, v183
    buffer_store_dwordx4 v[180:183], v209, s[56:59], s74 offen offset:2048 sc1
    s_waitcnt vmcnt(13)
    s_barrier
    v_pk_mul_f32 v[48:49], v[48:49], s[70:71]
    v_pk_mul_f32 v[50:51], v[50:51], s[70:71]
    v_pk_mul_f32 v[52:53], v[52:53], s[70:71]
    v_pk_mul_f32 v[54:55], v[54:55], s[70:71]
    v_exp_f32 v48, v48
    v_exp_f32 v49, v49
    v_exp_f32 v50, v50
    v_exp_f32 v51, v51
    v_exp_f32 v52, v52
    v_exp_f32 v53, v53
    v_exp_f32 v54, v54
    v_exp_f32 v55, v55
    v_pk_add_f32 v[48:49], v[48:49], s[72:73]
    v_pk_add_f32 v[50:51], v[50:51], s[72:73]
    v_pk_add_f32 v[52:53], v[52:53], s[72:73]
    v_pk_add_f32 v[54:55], v[54:55], s[72:73]
    v_rcp_f32 v48, v48
    v_rcp_f32 v49, v49
    v_rcp_f32 v50, v50
    v_rcp_f32 v51, v51
    v_rcp_f32 v52, v52
    v_rcp_f32 v53, v53
    v_rcp_f32 v54, v54
    v_rcp_f32 v55, v55
    v_pk_mul_f32 v[48:49], v[48:49], v[112:113]
    v_pk_mul_f32 v[50:51], v[50:51], v[114:115]
    v_pk_mul_f32 v[52:53], v[52:53], v[116:117]
    v_pk_mul_f32 v[54:55], v[54:55], v[118:119]
    v_cvt_pk_bf16_f32 v184, v48, v49
    v_cvt_pk_bf16_f32 v185, v50, v51
    v_cvt_pk_bf16_f32 v186, v52, v53
    v_cvt_pk_bf16_f32 v187, v54, v55
    s_nop 1
    v_permlane32_swap_b32 v184, v186
    v_permlane32_swap_b32 v185, v187
    buffer_store_dwordx4 v[184:187], v209, s[56:59], s74 offen offset:1024 sc1
    s_waitcnt vmcnt(1)
    s_barrier
    v_pk_mul_f32 v[56:57], v[56:57], s[70:71]
    v_pk_mul_f32 v[58:59], v[58:59], s[70:71]
    v_pk_mul_f32 v[60:61], v[60:61], s[70:71]
    v_pk_mul_f32 v[62:63], v[62:63], s[70:71]
    v_exp_f32 v56, v56
    v_exp_f32 v57, v57
    v_exp_f32 v58, v58
    v_exp_f32 v59, v59
    v_exp_f32 v60, v60
    v_exp_f32 v61, v61
    v_exp_f32 v62, v62
    v_exp_f32 v63, v63
    v_pk_add_f32 v[56:57], v[56:57], s[72:73]
    v_pk_add_f32 v[58:59], v[58:59], s[72:73]
    v_pk_add_f32 v[60:61], v[60:61], s[72:73]
    v_pk_add_f32 v[62:63], v[62:63], s[72:73]
    v_rcp_f32 v56, v56
    v_rcp_f32 v57, v57
    v_rcp_f32 v58, v58
    v_rcp_f32 v59, v59
    v_rcp_f32 v60, v60
    v_rcp_f32 v61, v61
    v_rcp_f32 v62, v62
    v_rcp_f32 v63, v63
    v_pk_mul_f32 v[56:57], v[56:57], v[120:121]
    v_pk_mul_f32 v[58:59], v[58:59], v[122:123]
    v_pk_mul_f32 v[60:61], v[60:61], v[124:125]
    v_pk_mul_f32 v[62:63], v[62:63], v[126:127]
    v_cvt_pk_bf16_f32 v188, v56, v57
    v_cvt_pk_bf16_f32 v189, v58, v59
    v_cvt_pk_bf16_f32 v190, v60, v61
    v_cvt_pk_bf16_f32 v191, v62, v63
    s_nop 1
    v_permlane32_swap_b32 v188, v190
    v_permlane32_swap_b32 v189, v191
    buffer_store_dwordx4 v[188:191], v209, s[56:59], s74 offen offset:3072 sc1
    s_branch TB_end
TB_g1:
    s_mov_b32 s65, 0
    s_add_u32 s69, s75, 0
    s_and_b32 s69, s69, 7
    s_lshl_b32 s77, s69, 7
    s_add_u32 s77, s77, s60
    s_mul_i32 s78, s69, 229376
    s_add_u32 s78, s78, s61
    s_add_u32 s68, s65, s64
    s_add_u32 m0, s68, 0
    s_nop 0
    buffer_load_dwordx4 v200, s[44:47], s77 offen lds
    s_add_u32 m0, s68, 1024
    s_nop 0
    buffer_load_dwordx4 v201, s[44:47], s77 offen lds
    s_add_u32 m0, s68, 2048
    s_nop 0
    buffer_load_dwordx4 v202, s[44:47], s77 offen lds
    s_add_u32 m0, s68, 3072
    s_nop 0
    buffer_load_dwordx4 v203, s[44:47], s77 offen lds
    s_add_u32 m0, s68, 16384
    s_nop 0
    buffer_load_dwordx4 v204, s[48:51], s78 offen lds
    s_add_u32 m0, s68, 17408
    s_nop 0
    buffer_load_dwordx4 v205, s[48:51], s78 offen lds
    s_add_u32 m0, s68, 18432
    s_nop 0
    buffer_load_dwordx4 v206, s[48:51], s78 offen lds
    s_add_u32 m0, s68, 19456
    s_nop 0
    buffer_load_dwordx4 v207, s[48:51], s78 offen lds
    s_add_u32 m0, s68, 32768
    s_nop 0
    buffer_load_dwordx4 v204, s[52:55], s78 offen lds
    s_add_u32 m0, s68, 33792
    s_nop 0
    buffer_load_dwordx4 v205, s[52:55], s78 offen lds
    s_add_u32 m0, s68, 34816
    s_nop 0
    buffer_load_dwordx4 v206, s[52:55], s78 offen lds
    s_add_u32 m0, s68, 35840
    s_nop 0
    buffer_load_dwordx4 v207, s[52:55], s78 offen lds
    s_add_u32 s65, s65, 49152
    s_cmp_eq_u32 s65, 147456
    s_cselect_b32 s65, 0, s65
    s_add_u32 s69, s75, 1
    s_and_b32 s69, s69, 7
    s_lshl_b32 s77, s69, 7
    s_add_u32 s77, s77, s60
    s_mul_i32 s78, s69, 229376
    s_add_u32 s78, s78, s61
    s_add_u32 s68, s65, s64
    s_add_u32 m0, s68, 0
    s_nop 0
    buffer_load_dwordx4 v200, s[44:47], s77 offen lds
    s_add_u32 m0, s68, 1024
    s_nop 0
    buffer_load_dwordx4 v201, s[44:47], s77 offen lds
    s_add_u32 m0, s68, 2048
    s_nop 0
    buffer_load_dwordx4 v202, s[44:47], s77 offen lds
    s_add_u32 m0, s68, 3072
    s_nop 0
    buffer_load_dwordx4 v203, s[44:47], s77 offen lds
    s_add_u32 m0, s68, 16384
    s_nop 0
    buffer_load_dwordx4 v204, s[48:51], s78 offen lds
    s_add_u32 m0, s68, 17408
    s_nop 0
    buffer_load_dwordx4 v205, s[48:51], s78 offen lds
    s_add_u32 m0, s68, 18432
    s_nop 0
    buffer_load_dwordx4 v206, s[48:51], s78 offen lds
    s_add_u32 m0, s68, 19456
    s_nop 0
    buffer_load_dwordx4 v207, s[48:51], s78 offen lds
    s_add_u32 m0, s68, 32768
    s_nop 0
    buffer_load_dwordx4 v204, s[52:55], s78 offen lds
    s_add_u32 m0, s68, 33792
    s_nop 0
    buffer_load_dwordx4 v205, s[52:55], s78 offen lds
    s_add_u32 m0, s68, 34816
    s_nop 0
    buffer_load_dwordx4 v206, s[52:55], s78 offen lds
    s_add_u32 m0, s68, 35840
    s_nop 0
    buffer_load_dwordx4 v207, s[52:55], s78 offen lds
    s_add_u32 s65, s65, 49152
    s_cmp_eq_u32 s65, 147456
    s_cselect_b32 s65, 0, s65
    s_waitcnt vmcnt(12)
    s_barrier
    s_add_u32 s69, s75, 2
    s_and_b32 s69, s69, 7
    s_lshl_b32 s77, s69, 7
    s_add_u32 s77, s77, s60
    s_mul_i32 s78, s69, 229376
    s_add_u32 s78, s78, s61
    s_add_u32 s68, s65, s64
    s_add_u32 m0, s68, 0
    s_nop 0
    buffer_load_dwordx4 v200, s[44:47], s77 offen lds
    s_add_u32 m0, s68, 1024
    s_nop 0
    buffer_load_dwordx4 v201, s[44:47], s77 offen lds
    s_add_u32 m0, s68, 2048
    s_nop 0
    buffer_load_dwordx4 v202, s[44:47], s77 offen lds
    s_add_u32 m0, s68, 3072
    s_nop 0
    buffer_load_dwordx4 v203, s[44:47], s77 offen lds
    s_add_u32 m0, s68, 16384
    s_nop 0
    buffer_load_dwordx4 v204, s[48:51], s78 offen lds
    s_add_u32 m0, s68, 17408
    s_nop 0
    buffer_load_dwordx4 v205, s[48:51], s78 offen lds
    s_add_u32 m0, s68, 18432
    s_nop 0
    buffer_load_dwordx4 v206, s[48:51], s78 offen lds
    s_add_u32 m0, s68, 19456
    s_nop 0
    buffer_load_dwordx4 v207, s[48:51], s78 offen lds
    s_add_u32 m0, s68, 32768
    s_nop 0
    buffer_load_dwordx4 v204, s[52:55], s78 offen lds
    s_add_u32 m0, s68, 33792
    s_nop 0
    buffer_load_dwordx4 v205, s[52:55], s78 offen lds
    s_add_u32 m0, s68, 34816
    s_nop 0
    buffer_load_dwordx4 v206, s[52:55], s78 offen lds
    s_add_u32 m0, s68, 35840
    s_nop 0
    buffer_load_dwordx4 v207, s[52:55], s78 offen lds
    s_add_u32 s65, s65, 49152
    s_cmp_eq_u32 s65, 147456
    s_cselect_b32 s65, 0, s65
    s_waitcnt vmcnt(12)
    s_barrier
    s_add_u32 s69, s75, 3
    s_and_b32 s69, s69, 7
    s_lshl_b32 s77, s69, 7
    s_add_u32 s77, s77, s60
    s_mul_i32 s78, s69, 229376
    s_add_u32 s78, s78, s61
    s_add_u32 s68, s65, s64
    s_add_u32 m0, s68, 0
    s_nop 0
    buffer_load_dwordx4 v200, s[44:47], s77 offen lds
    s_add_u32 m0, s68, 1024
    s_nop 0
    buffer_load_dwordx4 v201, s[44:47], s77 offen lds
    s_add_u32 m0, s68, 2048
    s_nop 0
    buffer_load_dwordx4 v202, s[44:47], s77 offen lds
    s_add_u32 m0, s68, 3072
    s_nop 0
    buffer_load_dwordx4 v203, s[44:47], s77 offen lds
    s_add_u32 m0, s68, 16384
    s_nop 0
    buffer_load_dwordx4 v204, s[48:51], s78 offen lds
    s_add_u32 m0, s68, 17408
    s_nop 0
    buffer_load_dwordx4 v205, s[48:51], s78 offen lds
    s_add_u32 m0, s68, 18432
    s_nop 0
    buffer_load_dwordx4 v206, s[48:51], s78 offen lds
    s_add_u32 m0, s68, 19456
    s_nop 0
    buffer_load_dwordx4 v207, s[48:51], s78 offen lds
    s_add_u32 m0, s68, 32768
    s_nop 0
    buffer_load_dwordx4 v204, s[52:55], s78 offen lds
    s_add_u32 m0, s68, 33792
    s_nop 0
    buffer_load_dwordx4 v205, s[52:55], s78 offen lds
    s_add_u32 m0, s68, 34816
    s_nop 0
    buffer_load_dwordx4 v206, s[52:55], s78 offen lds
    s_add_u32 m0, s68, 35840
    s_nop 0
    buffer_load_dwordx4 v207, s[52:55], s78 offen lds
    s_add_u32 s65, s65, 49152
    s_cmp_eq_u32 s65, 147456
    s_cselect_b32 s65, 0, s65
    s_waitcnt vmcnt(12)
    s_barrier
    s_add_u32 s69, s75, 4
    s_and_b32 s69, s69, 7
    s_lshl_b32 s77, s69, 7
    s_add_u32 s77, s77, s60
    s_mul_i32 s78, s69, 229376
    s_add_u32 s78, s78, s61
    s_add_u32 s68, s65, s64
    s_add_u32 m0, s68, 0
    s_nop 0
    buffer_load_dwordx4 v200, s[44:47], s77 offen lds
    s_add_u32 m0, s68, 1024
    s_nop 0
    buffer_load_dwordx4 v201, s[44:47], s77 offen lds
    s_add_u32 m0, s68, 2048
    s_nop 0
    buffer_load_dwordx4 v202, s[44:47], s77 offen lds
    s_add_u32 m0, s68, 3072
    s_nop 0
    buffer_load_dwordx4 v203, s[44:47], s77 offen lds
    s_add_u32 m0, s68, 16384
    s_nop 0
    buffer_load_dwordx4 v204, s[48:51], s78 offen lds
    s_add_u32 m0, s68, 17408
    s_nop 0
    buffer_load_dwordx4 v205, s[48:51], s78 offen lds
    s_add_u32 m0, s68, 18432
    s_nop 0
    buffer_load_dwordx4 v206, s[48:51], s78 offen lds
    s_add_u32 m0, s68, 19456
    s_nop 0
    buffer_load_dwordx4 v207, s[48:51], s78 offen lds
    s_add_u32 m0, s68, 32768
    s_nop 0
    buffer_load_dwordx4 v204, s[52:55], s78 offen lds
    s_add_u32 m0, s68, 33792
    s_nop 0
    buffer_load_dwordx4 v205, s[52:55], s78 offen lds
    s_add_u32 m0, s68, 34816
    s_nop 0
    buffer_load_dwordx4 v206, s[52:55], s78 offen lds
    s_add_u32 m0, s68, 35840
    s_nop 0
    buffer_load_dwordx4 v207, s[52:55], s78 offen lds
    s_add_u32 s65, s65, 49152
    s_cmp_eq_u32 s65, 147456
    s_cselect_b32 s65, 0, s65
    s_waitcnt vmcnt(12)
    s_barrier
    s_add_u32 s69, s75, 5
    s_and_b32 s69, s69, 7
    s_lshl_b32 s77, s69, 7
    s_add_u32 s77, s77, s60
    s_mul_i32 s78, s69, 229376
    s_add_u32 s78, s78, s61
    s_add_u32 s68, s65, s64
    s_add_u32 m0, s68, 0
    s_nop 0
    buffer_load_dwordx4 v200, s[44:47], s77 offen lds
    s_add_u32 m0, s68, 1024
    s_nop 0
    buffer_load_dwordx4 v201, s[44:47], s77 offen lds
    s_add_u32 m0, s68, 2048
    s_nop 0
    buffer_load_dwordx4 v202, s[44:47], s77 offen lds
    s_add_u32 m0, s68, 3072
    s_nop 0
    buffer_load_dwordx4 v203, s[44:47], s77 offen lds
    s_add_u32 m0, s68, 16384
    s_nop 0
    buffer_load_dwordx4 v204, s[48:51], s78 offen lds
    s_add_u32 m0, s68, 17408
    s_nop 0
    buffer_load_dwordx4 v205, s[48:51], s78 offen lds
    s_add_u32 m0, s68, 18432
    s_nop 0
    buffer_load_dwordx4 v206, s[48:51], s78 offen lds
    s_add_u32 m0, s68, 19456
    s_nop 0
    buffer_load_dwordx4 v207, s[48:51], s78 offen lds
    s_add_u32 m0, s68, 32768
    s_nop 0
    buffer_load_dwordx4 v204, s[52:55], s78 offen lds
    s_add_u32 m0, s68, 33792
    s_nop 0
    buffer_load_dwordx4 v205, s[52:55], s78 offen lds
    s_add_u32 m0, s68, 34816
    s_nop 0
    buffer_load_dwordx4 v206, s[52:55], s78 offen lds
    s_add_u32 m0, s68, 35840
    s_nop 0
    buffer_load_dwordx4 v207, s[52:55], s78 offen lds
    s_add_u32 s65, s65, 49152
    s_cmp_eq_u32 s65, 147456
    s_cselect_b32 s65, 0, s65
    s_waitcnt vmcnt(12)
    s_barrier
    s_add_u32 s69, s75, 6
    s_and_b32 s69, s69, 7
    s_lshl_b32 s77, s69, 7
    s_add_u32 s77, s77, s60
    s_mul_i32 s78, s69, 229376
    s_add_u32 s78, s78, s61
    s_add_u32 s68, s65, s64
    s_add_u32 m0, s68, 0
    s_nop 0
    buffer_load_dwordx4 v200, s[44:47], s77 offen lds
    s_add_u32 m0, s68, 1024
    s_nop 0
    buffer_load_dwordx4 v201, s[44:47], s77 offen lds
    s_add_u32 m0, s68, 2048
    s_nop 0
    buffer_load_dwordx4 v202, s[44:47], s77 offen lds
    s_add_u32 m0, s68, 3072
    s_nop 0
    buffer_load_dwordx4 v203, s[44:47], s77 offen lds
    s_add_u32 m0, s68, 16384
    s_nop 0
    buffer_load_dwordx4 v204, s[48:51], s78 offen lds
    s_add_u32 m0, s68, 17408
    s_nop 0
    buffer_load_dwordx4 v205, s[48:51], s78 offen lds
    s_add_u32 m0, s68, 18432
    s_nop 0
    buffer_load_dwordx4 v206, s[48:51], s78 offen lds
    s_add_u32 m0, s68, 19456
    s_nop 0
    buffer_load_dwordx4 v207, s[48:51], s78 offen lds
    s_add_u32 m0, s68, 32768
    s_nop 0
    buffer_load_dwordx4 v204, s[52:55], s78 offen lds
    s_add_u32 m0, s68, 33792
    s_nop 0
    buffer_load_dwordx4 v205, s[52:55], s78 offen lds
    s_add_u32 m0, s68, 34816
    s_nop 0
    buffer_load_dwordx4 v206, s[52:55], s78 offen lds
    s_add_u32 m0, s68, 35840
    s_nop 0
    buffer_load_dwordx4 v207, s[52:55], s78 offen lds
    s_add_u32 s65, s65, 49152
    s_cmp_eq_u32 s65, 147456
    s_cselect_b32 s65, 0, s65
    s_waitcnt vmcnt(12)
    s_barrier
    s_add_u32 s69, s75, 7
    s_and_b32 s69, s69, 7
    s_lshl_b32 s77, s69, 7
    s_add_u32 s77, s77, s60
    s_mul_i32 s78, s69, 229376
    s_add_u32 s78, s78, s61
    s_add_u32 s68, s65, s64
    s_add_u32 m0, s68, 0
    s_nop 0
    buffer_load_dwordx4 v200, s[44:47], s77 offen lds
    s_add_u32 m0, s68, 1024
    s_nop 0
    buffer_load_dwordx4 v201, s[44:47], s77 offen lds
    s_add_u32 m0, s68, 2048
    s_nop 0
    buffer_load_dwordx4 v202, s[44:47], s77 offen lds
    s_add_u32 m0, s68, 3072
    s_nop 0
    buffer_load_dwordx4 v203, s[44:47], s77 offen lds
    s_add_u32 m0, s68, 16384
    s_nop 0
    buffer_load_dwordx4 v204, s[48:51], s78 offen lds
    s_add_u32 m0, s68, 17408
    s_nop 0
    buffer_load_dwordx4 v205, s[48:51], s78 offen lds
    s_add_u32 m0, s68, 18432
    s_nop 0
    buffer_load_dwordx4 v206, s[48:51], s78 offen lds
    s_add_u32 m0, s68, 19456
    s_nop 0
    buffer_load_dwordx4 v207, s[48:51], s78 offen lds
    s_add_u32 m0, s68, 32768
    s_nop 0
    buffer_load_dwordx4 v204, s[52:55], s78 offen lds
    s_add_u32 m0, s68, 33792
    s_nop 0
    buffer_load_dwordx4 v205, s[52:55], s78 offen lds
    s_add_u32 m0, s68, 34816
    s_nop 0
    buffer_load_dwordx4 v206, s[52:55], s78 offen lds
    s_add_u32 m0, s68, 35840
    s_nop 0
    buffer_load_dwordx4 v207, s[52:55], s78 offen lds
    s_add_u32 s65, s65, 49152
    s_cmp_eq_u32 s65, 147456
    s_cselect_b32 s65, 0, s65
    s_waitcnt vmcnt(12)
    s_barrier
    s_add_u32 s69, s75, 0
    s_and_b32 s69, s69, 7
    s_lshl_b32 s77, s69, 7
    s_add_u32 s77, s77, s60
    s_add_u32 s77, s77, 131072
    s_mul_i32 s78, s69, 229376
    s_add_u32 s78, s78, s61
    s_add_u32 s68, s65, s64
    s_add_u32 m0, s68, 0
    s_nop 0
    buffer_load_dwordx4 v200, s[44:47], s77 offen lds
    s_add_u32 m0, s68, 1024
    s_nop 0
    buffer_load_dwordx4 v201, s[44:47], s77 offen lds
    s_add_u32 m0, s68, 2048
    s_nop 0
    buffer_load_dwordx4 v202, s[44:47], s77 offen lds
    s_add_u32 m0, s68, 3072
    s_nop 0
    buffer_load_dwordx4 v203, s[44:47], s77 offen lds
    s_add_u32 m0, s68, 16384
    s_nop 0
    buffer_load_dwordx4 v204, s[48:51], s78 offen lds
    s_add_u32 m0, s68, 17408
    s_nop 0
    buffer_load_dwordx4 v205, s[48:51], s78 offen lds
    s_add_u32 m0, s68, 18432
    s_nop 0
    buffer_load_dwordx4 v206, s[48:51], s78 offen lds
    s_add_u32 m0, s68, 19456
    s_nop 0
    buffer_load_dwordx4 v207, s[48:51], s78 offen lds
    s_add_u32 m0, s68, 32768
    s_nop 0
    buffer_load_dwordx4 v204, s[52:55], s78 offen lds
    s_add_u32 m0, s68, 33792
    s_nop 0
    buffer_load_dwordx4 v205, s[52:55], s78 offen lds
    s_add_u32 m0, s68, 34816
    s_nop 0
    buffer_load_dwordx4 v206, s[52:55], s78 offen lds
    s_add_u32 m0, s68, 35840
    s_nop 0
    buffer_load_dwordx4 v207, s[52:55], s78 offen lds
    s_add_u32 s65, s65, 49152
    s_cmp_eq_u32 s65, 147456
    s_cselect_b32 s65, 0, s65
    s_waitcnt vmcnt(12)
    s_barrier
    s_add_u32 s69, s75, 1
    s_and_b32 s69, s69, 7
    s_lshl_b32 s77, s69, 7
    s_add_u32 s77, s77, s60
    s_add_u32 s77, s77, 131072
    s_mul_i32 s78, s69, 229376
    s_add_u32 s78, s78, s61
    s_add_u32 s68, s65, s64
    s_add_u32 m0, s68, 0
    s_nop 0
    buffer_load_dwordx4 v200, s[44:47], s77 offen lds
    s_add_u32 m0, s68, 1024
    s_nop 0
    buffer_load_dwordx4 v201, s[44:47], s77 offen lds
    s_add_u32 m0, s68, 2048
    s_nop 0
    buffer_load_dwordx4 v202, s[44:47], s77 offen lds
    s_add_u32 m0, s68, 3072
    s_nop 0
    buffer_load_dwordx4 v203, s[44:47], s77 offen lds
    s_add_u32 m0, s68, 16384
    s_nop 0
    buffer_load_dwordx4 v204, s[48:51], s78 offen lds
    s_add_u32 m0, s68, 17408
    s_nop 0
    buffer_load_dwordx4 v205, s[48:51], s78 offen lds
    s_add_u32 m0, s68, 18432
    s_nop 0
    buffer_load_dwordx4 v206, s[48:51], s78 offen lds
    s_add_u32 m0, s68, 19456
    s_nop 0
    buffer_load_dwordx4 v207, s[48:51], s78 offen lds
    s_add_u32 m0, s68, 32768
    s_nop 0
    buffer_load_dwordx4 v204, s[52:55], s78 offen lds
    s_add_u32 m0, s68, 33792
    s_nop 0
    buffer_load_dwordx4 v205, s[52:55], s78 offen lds
    s_add_u32 m0, s68, 34816
    s_nop 0
    buffer_load_dwordx4 v206, s[52:55], s78 offen lds
    s_add_u32 m0, s68, 35840
    s_nop 0
    buffer_load_dwordx4 v207, s[52:55], s78 offen lds
    s_add_u32 s65, s65, 49152
    s_cmp_eq_u32 s65, 147456
    s_cselect_b32 s65, 0, s65
    s_add_u32 s74, s74, 720896
    s_mov_b32 s62, 98304
    v_mov_b32 v0, 0
    v_mov_b32 v1, 0
    v_mov_b32 v2, 0
    v_mov_b32 v3, 0
    v_mov_b32 v4, 0
    v_mov_b32 v5, 0
    v_mov_b32 v6, 0
    v_mov_b32 v7, 0
    v_mov_b32 v8, 0
    v_mov_b32 v9, 0
    v_mov_b32 v10, 0
    v_mov_b32 v11, 0
    v_mov_b32 v12, 0
    v_mov_b32 v13, 0
    v_mov_b32 v14, 0
    v_mov_b32 v15, 0
    v_mov_b32 v16, 0
    v_mov_b32 v17, 0
    v_mov_b32 v18, 0
    v_mov_b32 v19, 0
    v_mov_b32 v20, 0
    v_mov_b32 v21, 0
    v_mov_b32 v22, 0
    v_mov_b32 v23, 0
    v_mov_b32 v24, 0
    v_mov_b32 v25, 0
    v_mov_b32 v26, 0
    v_mov_b32 v27, 0
    v_mov_b32 v28, 0
    v_mov_b32 v29, 0
    v_mov_b32 v30, 0
    v_mov_b32 v31, 0
    v_mov_b32 v32, 0
    v_mov_b32 v33, 0
    v_mov_b32 v34, 0
    v_mov_b32 v35, 0
    v_mov_b32 v36, 0
    v_mov_b32 v37, 0
    v_mov_b32 v38, 0
    v_mov_b32 v39, 0
    v_mov_b32 v40, 0
    v_mov_b32 v41, 0
    v_mov_b32 v42, 0
    v_mov_b32 v43, 0
    v_mov_b32 v44, 0
    v_mov_b32 v45, 0
    v_mov_b32 v46, 0
    v_mov_b32 v47, 0
    v_mov_b32 v48, 0
    v_mov_b32 v49, 0
    v_mov_b32 v50, 0
    v_mov_b32 v51, 0
    v_mov_b32 v52, 0
    v_mov_b32 v53, 0
    v_mov_b32 v54, 0
    v_mov_b32 v55, 0
    v_mov_b32 v56, 0
    v_mov_b32 v57, 0
    v_mov_b32 v58, 0
    v_mov_b32 v59, 0
    v_mov_b32 v60, 0
    v_mov_b32 v61, 0
    v_mov_b32 v62, 0
    v_mov_b32 v63, 0
    v_mov_b32 v64, 0
    v_mov_b32 v65, 0
    v_mov_b32 v66, 0
    v_mov_b32 v67, 0
    v_mov_b32 v68, 0
    v_mov_b32 v69, 0
    v_mov_b32 v70, 0
    v_mov_b32 v71, 0
    v_mov_b32 v72, 0
    v_mov_b32 v73, 0
    v_mov_b32 v74, 0
    v_mov_b32 v75, 0
    v_mov_b32 v76, 0
    v_mov_b32 v77, 0
    v_mov_b32 v78, 0
    v_mov_b32 v79, 0
    v_mov_b32 v80, 0
    v_mov_b32 v81, 0
    v_mov_b32 v82, 0
    v_mov_b32 v83, 0
    v_mov_b32 v84, 0
    v_mov_b32 v85, 0
    v_mov_b32 v86, 0
    v_mov_b32 v87, 0
    v_mov_b32 v88, 0
    v_mov_b32 v89, 0
    v_mov_b32 v90, 0
    v_mov_b32 v91, 0
    v_mov_b32 v92, 0
    v_mov_b32 v93, 0
    v_mov_b32 v94, 0
    v_mov_b32 v95, 0
    v_mov_b32 v96, 0
    v_mov_b32 v97, 0
    v_mov_b32 v98, 0
    v_mov_b32 v99, 0
    v_mov_b32 v100, 0
    v_mov_b32 v101, 0
    v_mov_b32 v102, 0
    v_mov_b32 v103, 0
    v_mov_b32 v104, 0
    v_mov_b32 v105, 0
    v_mov_b32 v106, 0
    v_mov_b32 v107, 0
    v_mov_b32 v108, 0
    v_mov_b32 v109, 0
    v_mov_b32 v110, 0
    v_mov_b32 v111, 0
    v_mov_b32 v112, 0
    v_mov_b32 v113, 0
    v_mov_b32 v114, 0
    v_mov_b32 v115, 0
    v_mov_b32 v116, 0
    v_mov_b32 v117, 0
    v_mov_b32 v118, 0
    v_mov_b32 v119, 0
    v_mov_b32 v120, 0
    v_mov_b32 v121, 0
    v_mov_b32 v122, 0
    v_mov_b32 v123, 0
    v_mov_b32 v124, 0
    v_mov_b32 v125, 0
    v_mov_b32 v126, 0
    v_mov_b32 v127, 0
    v_add_u32 v224, s62, v192
    v_add_u32 v225, s62, v193
    v_add_u32 v226, s62, v194
    v_add_u32 v227, s62, v195
    v_add_u32 v228, s62, v196
    v_add_u32 v229, s62, v197
    s_waitcnt vmcnt(12)
    s_barrier
    ds_read_b128 v[128:131], v224 offset:0
    ds_read_b128 v[132:135], v224 offset:4096
    ds_read_b64_tr_b16 v[136:137], v228 offset:0
    ds_read_b64_tr_b16 v[138:139], v228 offset:1024
    ds_read_b64_tr_b16 v[140:141], v229 offset:0
    ds_read_b64_tr_b16 v[142:143], v229 offset:1024
    ds_read_b64_tr_b16 v[144:145], v228 offset:16384
    ds_read_b64_tr_b16 v[146:147], v228 offset:17408
    ds_read_b64_tr_b16 v[148:149], v229 offset:16384
    ds_read_b64_tr_b16 v[150:151], v229 offset:17408
    s_mov_b32 s63, 4
TB_cl_5:
    s_add_u32 s62, s62, 49152
    s_cmp_eq_u32 s62, 147456
    s_cselect_b32 s62, 0, s62
    s_waitcnt lgkmcnt(0)
    v_mfma_f32_32x32x16_bf16 v[0:15], v[136:139], v[128:131], v[0:15]
    ds_read_b128 v[152:155], v225 offset:0
    ds_read_b128 v[156:159], v225 offset:4096
    v_mfma_f32_32x32x16_bf16 v[16:31], v[136:139], v[132:135], v[16:31]
    ds_read_b64_tr_b16 v[160:161], v228 offset:4096
    ds_read_b64_tr_b16 v[162:163], v228 offset:5120
    v_mfma_f32_32x32x16_bf16 v[32:47], v[140:143], v[128:131], v[32:47]
    ds_read_b64_tr_b16 v[164:165], v229 offset:4096
    ds_read_b64_tr_b16 v[166:167], v229 offset:5120
    v_mfma_f32_32x32x16_bf16 v[48:63], v[140:143], v[132:135], v[48:63]
    ds_read_b64_tr_b16 v[168:169], v228 offset:20480
    ds_read_b64_tr_b16 v[170:171], v228 offset:21504
    v_mfma_f32_32x32x16_bf16 v[64:79], v[144:147], v[128:131], v[64:79]
    ds_read_b64_tr_b16 v[172:173], v229 offset:20480
    ds_read_b64_tr_b16 v[174:175], v229 offset:21504
    v_mfma_f32_32x32x16_bf16 v[80:95], v[144:147], v[132:135], v[80:95]
    v_add_u32 v230, s62, v192
    v_add_u32 v231, s62, v193
    v_mfma_f32_32x32x16_bf16 v[96:111], v[148:151], v[128:131], v[96:111]
    v_add_u32 v232, s62, v194
    v_add_u32 v233, s62, v195
    v_mfma_f32_32x32x16_bf16 v[112:127], v[148:151], v[132:135], v[112:127]
    v_add_u32 v234, s62, v196
    v_add_u32 v235, s62, v197
    s_waitcnt lgkmcnt(0)
    v_mfma_f32_32x32x16_bf16 v[0:15], v[160:163], v[152:155], v[0:15]
    ds_read_b128 v[128:131], v226 offset:0
    ds_read_b128 v[132:135], v226 offset:4096
    v_mfma_f32_32x32x16_bf16 v[16:31], v[160:163], v[156:159], v[16:31]
    ds_read_b64_tr_b16 v[136:137], v228 offset:8192
    ds_read_b64_tr_b16 v[138:139], v228 offset:9216
    v_mfma_f32_32x32x16_bf16 v[32:47], v[164:167], v[152:155], v[32:47]
    ds_read_b64_tr_b16 v[140:141], v229 offset:8192
    ds_read_b64_tr_b16 v[142:143], v229 offset:9216
    v_mfma_f32_32x32x16_bf16 v[48:63], v[164:167], v[156:159], v[48:63]
    ds_read_b64_tr_b16 v[144:145], v228 offset:24576
    ds_read_b64_tr_b16 v[146:147], v228 offset:25600
    v_mfma_f32_32x32x16_bf16 v[64:79], v[168:171], v[152:155], v[64:79]
    ds_read_b64_tr_b16 v[148:149], v229 offset:24576
    ds_read_b64_tr_b16 v[150:151], v229 offset:25600
    v_mfma_f32_32x32x16_bf16 v[80:95], v[168:171], v[156:159], v[80:95]
    v_mfma_f32_32x32x16_bf16 v[96:111], v[172:175], v[152:155], v[96:111]
    v_mfma_f32_32x32x16_bf16 v[112:127], v[172:175], v[156:159], v[112:127]
    s_waitcnt lgkmcnt(0)
    v_mfma_f32_32x32x16_bf16 v[0:15], v[136:139], v[128:131], v[0:15]
    ds_read_b128 v[152:155], v227 offset:0
    ds_read_b128 v[156:159], v227 offset:4096
    v_mfma_f32_32x32x16_bf16 v[16:31], v[136:139], v[132:135], v[16:31]
    ds_read_b64_tr_b16 v[160:161], v228 offset:12288
    ds_read_b64_tr_b16 v[162:163], v228 offset:13312
    v_mfma_f32_32x32x16_bf16 v[32:47], v[140:143], v[128:131], v[32:47]
    ds_read_b64_tr_b16 v[164:165], v229 offset:12288
    ds_read_b64_tr_b16 v[166:167], v229 offset:13312
    v_mfma_f32_32x32x16_bf16 v[48:63], v[140:143], v[132:135], v[48:63]
    ds_read_b64_tr_b16 v[168:169], v228 offset:28672
    ds_read_b64_tr_b16 v[170:171], v228 offset:29696
    v_mfma_f32_32x32x16_bf16 v[64:79], v[144:147], v[128:131], v[64:79]
    ds_read_b64_tr_b16 v[172:173], v229 offset:28672
    ds_read_b64_tr_b16 v[174:175], v229 offset:29696
    v_mfma_f32_32x32x16_bf16 v[80:95], v[144:147], v[132:135], v[80:95]
    v_mfma_f32_32x32x16_bf16 v[96:111], v[148:151], v[128:131], v[96:111]
    v_mfma_f32_32x32x16_bf16 v[112:127], v[148:151], v[132:135], v[112:127]
    s_waitcnt lgkmcnt(0) vmcnt(0)
    s_barrier
    v_mfma_f32_32x32x16_bf16 v[0:15], v[160:163], v[152:155], v[0:15]
    ds_read_b128 v[128:131], v230 offset:0
    ds_read_b128 v[132:135], v230 offset:4096
    v_mfma_f32_32x32x16_bf16 v[16:31], v[160:163], v[156:159], v[16:31]
    ds_read_b64_tr_b16 v[136:137], v234 offset:0
    ds_read_b64_tr_b16 v[138:139], v234 offset:1024
    v_mfma_f32_32x32x16_bf16 v[32:47], v[164:167], v[152:155], v[32:47]
    ds_read_b64_tr_b16 v[140:141], v235 offset:0
    ds_read_b64_tr_b16 v[142:143], v235 offset:1024
    v_mfma_f32_32x32x16_bf16 v[48:63], v[164:167], v[156:159], v[48:63]
    ds_read_b64_tr_b16 v[144:145], v234 offset:16384
    ds_read_b64_tr_b16 v[146:147], v234 offset:17408
    v_mfma_f32_32x32x16_bf16 v[64:79], v[168:171], v[152:155], v[64:79]
    ds_read_b64_tr_b16 v[148:149], v235 offset:16384
    ds_read_b64_tr_b16 v[150:151], v235 offset:17408
    v_mfma_f32_32x32x16_bf16 v[80:95], v[168:171], v[156:159], v[80:95]
    v_mfma_f32_32x32x16_bf16 v[96:111], v[172:175], v[152:155], v[96:111]
    v_mfma_f32_32x32x16_bf16 v[112:127], v[172:175], v[156:159], v[112:127]
    s_sub_u32 s63, s63, 1
    s_cmp_eq_u32 s63, 0
    s_cbranch_scc1 TB_cz_6
    s_add_u32 s62, s62, 49152
    s_cmp_eq_u32 s62, 147456
    s_cselect_b32 s62, 0, s62
    s_waitcnt lgkmcnt(0)
    v_mfma_f32_32x32x16_bf16 v[0:15], v[136:139], v[128:131], v[0:15]
    ds_read_b128 v[152:155], v231 offset:0
    ds_read_b128 v[156:159], v231 offset:4096
    v_mfma_f32_32x32x16_bf16 v[16:31], v[136:139], v[132:135], v[16:31]
    ds_read_b64_tr_b16 v[160:161], v234 offset:4096
    ds_read_b64_tr_b16 v[162:163], v234 offset:5120
    v_mfma_f32_32x32x16_bf16 v[32:47], v[140:143], v[128:131], v[32:47]
    ds_read_b64_tr_b16 v[164:165], v235 offset:4096
    ds_read_b64_tr_b16 v[166:167], v235 offset:5120
    v_mfma_f32_32x32x16_bf16 v[48:63], v[140:143], v[132:135], v[48:63]
    ds_read_b64_tr_b16 v[168:169], v234 offset:20480
    ds_read_b64_tr_b16 v[170:171], v234 offset:21504
    v_mfma_f32_32x32x16_bf16 v[64:79], v[144:147], v[128:131], v[64:79]
    ds_read_b64_tr_b16 v[172:173], v235 offset:20480
    ds_read_b64_tr_b16 v[174:175], v235 offset:21504
    v_mfma_f32_32x32x16_bf16 v[80:95], v[144:147], v[132:135], v[80:95]
    v_add_u32 v224, s62, v192
    v_add_u32 v225, s62, v193
    v_mfma_f32_32x32x16_bf16 v[96:111], v[148:151], v[128:131], v[96:111]
    v_add_u32 v226, s62, v194
    v_add_u32 v227, s62, v195
    v_mfma_f32_32x32x16_bf16 v[112:127], v[148:151], v[132:135], v[112:127]
    v_add_u32 v228, s62, v196
    v_add_u32 v229, s62, v197
    s_waitcnt lgkmcnt(0)
    v_mfma_f32_32x32x16_bf16 v[0:15], v[160:163], v[152:155], v[0:15]
    ds_read_b128 v[128:131], v232 offset:0
    ds_read_b128 v[132:135], v232 offset:4096
    v_mfma_f32_32x32x16_bf16 v[16:31], v[160:163], v[156:159], v[16:31]
    ds_read_b64_tr_b16 v[136:137], v234 offset:8192
    ds_read_b64_tr_b16 v[138:139], v234 offset:9216
    v_mfma_f32_32x32x16_bf16 v[32:47], v[164:167], v[152:155], v[32:47]
    ds_read_b64_tr_b16 v[140:141], v235 offset:8192
    ds_read_b64_tr_b16 v[142:143], v235 offset:9216
    v_mfma_f32_32x32x16_bf16 v[48:63], v[164:167], v[156:159], v[48:63]
    ds_read_b64_tr_b16 v[144:145], v234 offset:24576
    ds_read_b64_tr_b16 v[146:147], v234 offset:25600
    v_mfma_f32_32x32x16_bf16 v[64:79], v[168:171], v[152:155], v[64:79]
    ds_read_b64_tr_b16 v[148:149], v235 offset:24576
    ds_read_b64_tr_b16 v[150:151], v235 offset:25600
    v_mfma_f32_32x32x16_bf16 v[80:95], v[168:171], v[156:159], v[80:95]
    v_mfma_f32_32x32x16_bf16 v[96:111], v[172:175], v[152:155], v[96:111]
    v_mfma_f32_32x32x16_bf16 v[112:127], v[172:175], v[156:159], v[112:127]
    s_waitcnt lgkmcnt(0)
    v_mfma_f32_32x32x16_bf16 v[0:15], v[136:139], v[128:131], v[0:15]
    ds_read_b128 v[152:155], v233 offset:0
    ds_read_b128 v[156:159], v233 offset:4096
    v_mfma_f32_32x32x16_bf16 v[16:31], v[136:139], v[132:135], v[16:31]
    ds_read_b64_tr_b16 v[160:161], v234 offset:12288
    ds_read_b64_tr_b16 v[162:163], v234 offset:13312
    v_mfma_f32_32x32x16_bf16 v[32:47], v[140:143], v[128:131], v[32:47]
    ds_read_b64_tr_b16 v[164:165], v235 offset:12288
    ds_read_b64_tr_b16 v[166:167], v235 offset:13312
    v_mfma_f32_32x32x16_bf16 v[48:63], v[140:143], v[132:135], v[48:63]
    ds_read_b64_tr_b16 v[168:169], v234 offset:28672
    ds_read_b64_tr_b16 v[170:171], v234 offset:29696
    v_mfma_f32_32x32x16_bf16 v[64:79], v[144:147], v[128:131], v[64:79]
    ds_read_b64_tr_b16 v[172:173], v235 offset:28672
    ds_read_b64_tr_b16 v[174:175], v235 offset:29696
    v_mfma_f32_32x32x16_bf16 v[80:95], v[144:147], v[132:135], v[80:95]
    v_mfma_f32_32x32x16_bf16 v[96:111], v[148:151], v[128:131], v[96:111]
    v_mfma_f32_32x32x16_bf16 v[112:127], v[148:151], v[132:135], v[112:127]
    s_waitcnt lgkmcnt(0) vmcnt(0)
    s_barrier
    v_mfma_f32_32x32x16_bf16 v[0:15], v[160:163], v[152:155], v[0:15]
    ds_read_b128 v[128:131], v224 offset:0
    ds_read_b128 v[132:135], v224 offset:4096
    v_mfma_f32_32x32x16_bf16 v[16:31], v[160:163], v[156:159], v[16:31]
    ds_read_b64_tr_b16 v[136:137], v228 offset:0
    ds_read_b64_tr_b16 v[138:139], v228 offset:1024
    v_mfma_f32_32x32x16_bf16 v[32:47], v[164:167], v[152:155], v[32:47]
    ds_read_b64_tr_b16 v[140:141], v229 offset:0
    ds_read_b64_tr_b16 v[142:143], v229 offset:1024
    v_mfma_f32_32x32x16_bf16 v[48:63], v[164:167], v[156:159], v[48:63]
    ds_read_b64_tr_b16 v[144:145], v228 offset:16384
    ds_read_b64_tr_b16 v[146:147], v228 offset:17408
    v_mfma_f32_32x32x16_bf16 v[64:79], v[168:171], v[152:155], v[64:79]
    ds_read_b64_tr_b16 v[148:149], v229 offset:16384
    ds_read_b64_tr_b16 v[150:151], v229 offset:17408
    v_mfma_f32_32x32x16_bf16 v[80:95], v[168:171], v[156:159], v[80:95]
    v_mfma_f32_32x32x16_bf16 v[96:111], v[172:175], v[152:155], v[96:111]
    v_mfma_f32_32x32x16_bf16 v[112:127], v[172:175], v[156:159], v[112:127]
    s_branch TB_cl_5
TB_cz_6:
    s_waitcnt lgkmcnt(0)
    v_mfma_f32_32x32x16_bf16 v[0:15], v[136:139], v[128:131], v[0:15]
    ds_read_b128 v[152:155], v231 offset:0
    ds_read_b128 v[156:159], v231 offset:4096
    v_mfma_f32_32x32x16_bf16 v[16:31], v[136:139], v[132:135], v[16:31]
    ds_read_b64_tr_b16 v[160:161], v234 offset:4096
    ds_read_b64_tr_b16 v[162:163], v234 offset:5120
    v_mfma_f32_32x32x16_bf16 v[32:47], v[140:143], v[128:131], v[32:47]
    ds_read_b64_tr_b16 v[164:165], v235 offset:4096
    ds_read_b64_tr_b16 v[166:167], v235 offset:5120
    v_mfma_f32_32x32x16_bf16 v[48:63], v[140:143], v[132:135], v[48:63]
    ds_read_b64_tr_b16 v[168:169], v234 offset:20480
    ds_read_b64_tr_b16 v[170:171], v234 offset:21504
    v_mfma_f32_32x32x16_bf16 v[64:79], v[144:147], v[128:131], v[64:79]
    ds_read_b64_tr_b16 v[172:173], v235 offset:20480
    ds_read_b64_tr_b16 v[174:175], v235 offset:21504
    v_mfma_f32_32x32x16_bf16 v[80:95], v[144:147], v[132:135], v[80:95]
    v_mfma_f32_32x32x16_bf16 v[96:111], v[148:151], v[128:131], v[96:111]
    v_mfma_f32_32x32x16_bf16 v[112:127], v[148:151], v[132:135], v[112:127]
    s_waitcnt lgkmcnt(0)
    v_mfma_f32_32x32x16_bf16 v[0:15], v[160:163], v[152:155], v[0:15]
    ds_read_b128 v[128:131], v232 offset:0
    ds_read_b128 v[132:135], v232 offset:4096
    v_mfma_f32_32x32x16_bf16 v[16:31], v[160:163], v[156:159], v[16:31]
    ds_read_b64_tr_b16 v[136:137], v234 offset:8192
    ds_read_b64_tr_b16 v[138:139], v234 offset:9216
    v_mfma_f32_32x32x16_bf16 v[32:47], v[164:167], v[152:155], v[32:47]
    ds_read_b64_tr_b16 v[140:141], v235 offset:8192
    ds_read_b64_tr_b16 v[142:143], v235 offset:9216
    v_mfma_f32_32x32x16_bf16 v[48:63], v[164:167], v[156:159], v[48:63]
    ds_read_b64_tr_b16 v[144:145], v234 offset:24576
    ds_read_b64_tr_b16 v[146:147], v234 offset:25600
    v_mfma_f32_32x32x16_bf16 v[64:79], v[168:171], v[152:155], v[64:79]
    ds_read_b64_tr_b16 v[148:149], v235 offset:24576
    ds_read_b64_tr_b16 v[150:151], v235 offset:25600
    v_mfma_f32_32x32x16_bf16 v[80:95], v[168:171], v[156:159], v[80:95]
    v_mfma_f32_32x32x16_bf16 v[96:111], v[172:175], v[152:155], v[96:111]
    v_mfma_f32_32x32x16_bf16 v[112:127], v[172:175], v[156:159], v[112:127]
    s_waitcnt lgkmcnt(0)
    v_mfma_f32_32x32x16_bf16 v[0:15], v[136:139], v[128:131], v[0:15]
    ds_read_b128 v[152:155], v233 offset:0
    ds_read_b128 v[156:159], v233 offset:4096
    v_mfma_f32_32x32x16_bf16 v[16:31], v[136:139], v[132:135], v[16:31]
    ds_read_b64_tr_b16 v[160:161], v234 offset:12288
    ds_read_b64_tr_b16 v[162:163], v234 offset:13312
    v_mfma_f32_32x32x16_bf16 v[32:47], v[140:143], v[128:131], v[32:47]
    ds_read_b64_tr_b16 v[164:165], v235 offset:12288
    ds_read_b64_tr_b16 v[166:167], v235 offset:13312
    v_mfma_f32_32x32x16_bf16 v[48:63], v[140:143], v[132:135], v[48:63]
    ds_read_b64_tr_b16 v[168:169], v234 offset:28672
    ds_read_b64_tr_b16 v[170:171], v234 offset:29696
    v_mfma_f32_32x32x16_bf16 v[64:79], v[144:147], v[128:131], v[64:79]
    ds_read_b64_tr_b16 v[172:173], v235 offset:28672
    ds_read_b64_tr_b16 v[174:175], v235 offset:29696
    v_mfma_f32_32x32x16_bf16 v[80:95], v[144:147], v[132:135], v[80:95]
    v_mfma_f32_32x32x16_bf16 v[96:111], v[148:151], v[128:131], v[96:111]
    v_mfma_f32_32x32x16_bf16 v[112:127], v[148:151], v[132:135], v[112:127]
    s_waitcnt lgkmcnt(0)
    v_mfma_f32_32x32x16_bf16 v[0:15], v[160:163], v[152:155], v[0:15]
    v_mfma_f32_32x32x16_bf16 v[16:31], v[160:163], v[156:159], v[16:31]
    v_mfma_f32_32x32x16_bf16 v[32:47], v[164:167], v[152:155], v[32:47]
    v_mfma_f32_32x32x16_bf16 v[48:63], v[164:167], v[156:159], v[48:63]
    v_mfma_f32_32x32x16_bf16 v[64:79], v[168:171], v[152:155], v[64:79]
    v_mfma_f32_32x32x16_bf16 v[80:95], v[168:171], v[156:159], v[80:95]
    v_mfma_f32_32x32x16_bf16 v[96:111], v[172:175], v[152:155], v[96:111]
    v_mfma_f32_32x32x16_bf16 v[112:127], v[172:175], v[156:159], v[112:127]
    s_nop 15
    s_nop 3
    v_pk_mul_f32 v[0:1], v[0:1], s[70:71]
    v_pk_mul_f32 v[2:3], v[2:3], s[70:71]
    v_pk_mul_f32 v[4:5], v[4:5], s[70:71]
    v_pk_mul_f32 v[6:7], v[6:7], s[70:71]
    v_exp_f32 v0, v0
    v_exp_f32 v1, v1
    v_exp_f32 v2, v2
    v_exp_f32 v3, v3
    v_exp_f32 v4, v4
    v_exp_f32 v5, v5
    v_exp_f32 v6, v6
    v_exp_f32 v7, v7
    v_pk_add_f32 v[0:1], v[0:1], s[72:73]
    v_pk_add_f32 v[2:3], v[2:3], s[72:73]
    v_pk_add_f32 v[4:5], v[4:5], s[72:73]
    v_pk_add_f32 v[6:7], v[6:7], s[72:73]
    v_rcp_f32 v0, v0
    v_rcp_f32 v1, v1
    v_rcp_f32 v2, v2
    v_rcp_f32 v3, v3
    v_rcp_f32 v4, v4
    v_rcp_f32 v5, v5
    v_rcp_f32 v6, v6
    v_rcp_f32 v7, v7
    v_pk_mul_f32 v[0:1], v[0:1], v[64:65]
    v_pk_mul_f32 v[2:3], v[2:3], v[66:67]
    v_pk_mul_f32 v[4:5], v[4:5], v[68:69]
    v_pk_mul_f32 v[6:7], v[6:7], v[70:71]
    v_cvt_pk_bf16_f32 v160, v0, v1
    v_cvt_pk_bf16_f32 v161, v2, v3
    v_cvt_pk_bf16_f32 v162, v4, v5
    v_cvt_pk_bf16_f32 v163, v6, v7
    s_nop 1
    v_permlane32_swap_b32 v160, v162
    v_permlane32_swap_b32 v161, v163
    buffer_store_dwordx4 v[160:163], v208, s[56:59], s74 offen offset:0 sc1
    v_pk_mul_f32 v[8:9], v[8:9], s[70:71]
    v_pk_mul_f32 v[10:11], v[10:11], s[70:71]
    v_pk_mul_f32 v[12:13], v[12:13], s[70:71]
    v_pk_mul_f32 v[14:15], v[14:15], s[70:71]
    v_exp_f32 v8, v8
    v_exp_f32 v9, v9
    v_exp_f32 v10, v10
    v_exp_f32 v11, v11
    v_exp_f32 v12, v12
    v_exp_f32 v13, v13
    v_exp_f32 v14, v14
    v_exp_f32 v15, v15
    v_pk_add_f32 v[8:9], v[8:9], s[72:73]
    v_pk_add_f32 v[10:11], v[10:11], s[72:73]
    v_pk_add_f32 v[12:13], v[12:13], s[72:73]
    v_pk_add_f32 v[14:15], v[14:15], s[72:73]
    v_rcp_f32 v8, v8
    v_rcp_f32 v9, v9
    v_rcp_f32 v10, v10
    v_rcp_f32 v11, v11
    v_rcp_f32 v12, v12
    v_rcp_f32 v13, v13
    v_rcp_f32 v14, v14
    v_rcp_f32 v15, v15
    v_pk_mul_f32 v[8:9], v[8:9], v[72:73]
    v_pk_mul_f32 v[10:11], v[10:11], v[74:75]
    v_pk_mul_f32 v[12:13], v[12:13], v[76:77]
    v_pk_mul_f32 v[14:15], v[14:15], v[78:79]
    v_cvt_pk_bf16_f32 v164, v8, v9
    v_cvt_pk_bf16_f32 v165, v10, v11
    v_cvt_pk_bf16_f32 v166, v12, v13
    v_cvt_pk_bf16_f32 v167, v14, v15
    s_nop 1
    v_permlane32_swap_b32 v164, v166
    v_permlane32_swap_b32 v165, v167
    buffer_store_dwordx4 v[164:167], v208, s[56:59], s74 offen offset:2048 sc1
    v_pk_mul_f32 v[16:17], v[16:17], s[70:71]
    v_pk_mul_f32 v[18:19], v[18:19], s[70:71]
    v_pk_mul_f32 v[20:21], v[20:21], s[70:71]
    v_pk_mul_f32 v[22:23], v[22:23], s[70:71]
    v_exp_f32 v16, v16
    v_exp_f32 v17, v17
    v_exp_f32 v18, v18
    v_exp_f32 v19, v19
    v_exp_f32 v20, v20
    v_exp_f32 v21, v21
    v_exp_f32 v22, v22
    v_exp_f32 v23, v23
    v_pk_add_f32 v[16:17], v[16:17], s[72:73]
    v_pk_add_f32 v[18:19], v[18:19], s[72:73]
    v_pk_add_f32 v[20:21], v[20:21], s[72:73]
    v_pk_add_f32 v[22:23], v[22:23], s[72:73]
    v_rcp_f32 v16, v16
    v_rcp_f32 v17, v17
    v_rcp_f32 v18, v18
    v_rcp_f32 v19, v19
    v_rcp_f32 v20, v20
    v_rcp_f32 v21, v21
    v_rcp_f32 v22, v22
    v_rcp_f32 v23, v23
    v_pk_mul_f32 v[16:17], v[16:17], v[80:81]
    v_pk_mul_f32 v[18:19], v[18:19], v[82:83]
    v_pk_mul_f32 v[20:21], v[20:21], v[84:85]
    v_pk_mul_f32 v[22:23], v[22:23], v[86:87]
    v_cvt_pk_bf16_f32 v168, v16, v17
    v_cvt_pk_bf16_f32 v169, v18, v19
    v_cvt_pk_bf16_f32 v170, v20, v21
    v_cvt_pk_bf16_f32 v171, v22, v23
    s_nop 1
    v_permlane32_swap_b32 v168, v170
    v_permlane32_swap_b32 v169, v171
    buffer_store_dwordx4 v[168:171], v208, s[56:59], s74 offen offset:1024 sc1
    v_pk_mul_f32 v[24:25], v[24:25], s[70:71]
    v_pk_mul_f32 v[26:27], v[26:27], s[70:71]
    v_pk_mul_f32 v[28:29], v[28:29], s[70:71]
    v_pk_mul_f32 v[30:31], v[30:31], s[70:71]
    v_exp_f32 v24, v24
    v_exp_f32 v25, v25
    v_exp_f32 v26, v26
    v_exp_f32 v27, v27
    v_exp_f32 v28, v28
    v_exp_f32 v29, v29
    v_exp_f32 v30, v30
    v_exp_f32 v31, v31
    v_pk_add_f32 v[24:25], v[24:25], s[72:73]
    v_pk_add_f32 v[26:27], v[26:27], s[72:73]
    v_pk_add_f32 v[28:29], v[28:29], s[72:73]
    v_pk_add_f32 v[30:31], v[30:31], s[72:73]
    v_rcp_f32 v24, v24
    v_rcp_f32 v25, v25
    v_rcp_f32 v26, v26
    v_rcp_f32 v27, v27
    v_rcp_f32 v28, v28
    v_rcp_f32 v29, v29
    v_rcp_f32 v30, v30
    v_rcp_f32 v31, v31
    v_pk_mul_f32 v[24:25], v[24:25], v[88:89]
    v_pk_mul_f32 v[26:27], v[26:27], v[90:91]
    v_pk_mul_f32 v[28:29], v[28:29], v[92:93]
    v_pk_mul_f32 v[30:31], v[30:31], v[94:95]
    v_cvt_pk_bf16_f32 v172, v24, v25
    v_cvt_pk_bf16_f32 v173, v26, v27
    v_cvt_pk_bf16_f32 v174, v28, v29
    v_cvt_pk_bf16_f32 v175, v30, v31
    s_nop 1
    v_permlane32_swap_b32 v172, v174
    v_permlane32_swap_b32 v173, v175
    buffer_store_dwordx4 v[172:175], v208, s[56:59], s74 offen offset:3072 sc1
    v_pk_mul_f32 v[32:33], v[32:33], s[70:71]
    v_pk_mul_f32 v[34:35], v[34:35], s[70:71]
    v_pk_mul_f32 v[36:37], v[36:37], s[70:71]
    v_pk_mul_f32 v[38:39], v[38:39], s[70:71]
    v_exp_f32 v32, v32
    v_exp_f32 v33, v33
    v_exp_f32 v34, v34
    v_exp_f32 v35, v35
    v_exp_f32 v36, v36
    v_exp_f32 v37, v37
    v_exp_f32 v38, v38
    v_exp_f32 v39, v39
    v_pk_add_f32 v[32:33], v[32:33], s[72:73]
    v_pk_add_f32 v[34:35], v[34:35], s[72:73]
    v_pk_add_f32 v[36:37], v[36:37], s[72:73]
    v_pk_add_f32 v[38:39], v[38:39], s[72:73]
    v_rcp_f32 v32, v32
    v_rcp_f32 v33, v33
    v_rcp_f32 v34, v34
    v_rcp_f32 v35, v35
    v_rcp_f32 v36, v36
    v_rcp_f32 v37, v37
    v_rcp_f32 v38, v38
    v_rcp_f32 v39, v39
    v_pk_mul_f32 v[32:33], v[32:33], v[96:97]
    v_pk_mul_f32 v[34:35], v[34:35], v[98:99]
    v_pk_mul_f32 v[36:37], v[36:37], v[100:101]
    v_pk_mul_f32 v[38:39], v[38:39], v[102:103]
    v_cvt_pk_bf16_f32 v176, v32, v33
    v_cvt_pk_bf16_f32 v177, v34, v35
    v_cvt_pk_bf16_f32 v178, v36, v37
    v_cvt_pk_bf16_f32 v179, v38, v39
    s_nop 1
    v_permlane32_swap_b32 v176, v178
    v_permlane32_swap_b32 v177, v179
    buffer_store_dwordx4 v[176:179], v209, s[56:59], s74 offen offset:0 sc1
    v_pk_mul_f32 v[40:41], v[40:41], s[70:71]
    v_pk_mul_f32 v[42:43], v[42:43], s[70:71]
    v_pk_mul_f32 v[44:45], v[44:45], s[70:71]
    v_pk_mul_f32 v[46:47], v[46:47], s[70:71]
    v_exp_f32 v40, v40
    v_exp_f32 v41, v41
    v_exp_f32 v42, v42
    v_exp_f32 v43, v43
    v_exp_f32 v44, v44
    v_exp_f32 v45, v45
    v_exp_f32 v46, v46
    v_exp_f32 v47, v47
    v_pk_add_f32 v[40:41], v[40:41], s[72:73]
    v_pk_add_f32 v[42:43], v[42:43], s[72:73]
    v_pk_add_f32 v[44:45], v[44:45], s[72:73]
    v_pk_add_f32 v[46:47], v[46:47], s[72:73]
    v_rcp_f32 v40, v40
    v_rcp_f32 v41, v41
    v_rcp_f32 v42, v42
    v_rcp_f32 v43, v43
    v_rcp_f32 v44, v44
    v_rcp_f32 v45, v45
    v_rcp_f32 v46, v46
    v_rcp_f32 v47, v47
    v_pk_mul_f32 v[40:41], v[40:41], v[104:105]
    v_pk_mul_f32 v[42:43], v[42:43], v[106:107]
    v_pk_mul_f32 v[44:45], v[44:45], v[108:109]
    v_pk_mul_f32 v[46:47], v[46:47], v[110:111]
    v_cvt_pk_bf16_f32 v180, v40, v41
    v_cvt_pk_bf16_f32 v181, v42, v43
    v_cvt_pk_bf16_f32 v182, v44, v45
    v_cvt_pk_bf16_f32 v183, v46, v47
    s_nop 1
    v_permlane32_swap_b32 v180, v182
    v_permlane32_swap_b32 v181, v183
    buffer_store_dwordx4 v[180:183], v209, s[56:59], s74 offen offset:2048 sc1
    v_pk_mul_f32 v[48:49], v[48:49], s[70:71]
    v_pk_mul_f32 v[50:51], v[50:51], s[70:71]
    v_pk_mul_f32 v[52:53], v[52:53], s[70:71]
    v_pk_mul_f32 v[54:55], v[54:55], s[70:71]
    v_exp_f32 v48, v48
    v_exp_f32 v49, v49
    v_exp_f32 v50, v50
    v_exp_f32 v51, v51
    v_exp_f32 v52, v52
    v_exp_f32 v53, v53
    v_exp_f32 v54, v54
    v_exp_f32 v55, v55
    v_pk_add_f32 v[48:49], v[48:49], s[72:73]
    v_pk_add_f32 v[50:51], v[50:51], s[72:73]
    v_pk_add_f32 v[52:53], v[52:53], s[72:73]
    v_pk_add_f32 v[54:55], v[54:55], s[72:73]
    v_rcp_f32 v48, v48
    v_rcp_f32 v49, v49
    v_rcp_f32 v50, v50
    v_rcp_f32 v51, v51
    v_rcp_f32 v52, v52
    v_rcp_f32 v53, v53
    v_rcp_f32 v54, v54
    v_rcp_f32 v55, v55
    v_pk_mul_f32 v[48:49], v[48:49], v[112:113]
    v_pk_mul_f32 v[50:51], v[50:51], v[114:115]
    v_pk_mul_f32 v[52:53], v[52:53], v[116:117]
    v_pk_mul_f32 v[54:55], v[54:55], v[118:119]
    v_cvt_pk_bf16_f32 v184, v48, v49
    v_cvt_pk_bf16_f32 v185, v50, v51
    v_cvt_pk_bf16_f32 v186, v52, v53
    v_cvt_pk_bf16_f32 v187, v54, v55
    s_nop 1
    v_permlane32_swap_b32 v184, v186
    v_permlane32_swap_b32 v185, v187
    buffer_store_dwordx4 v[184:187], v209, s[56:59], s74 offen offset:1024 sc1
    v_pk_mul_f32 v[56:57], v[56:57], s[70:71]
    v_pk_mul_f32 v[58:59], v[58:59], s[70:71]
    v_pk_mul_f32 v[60:61], v[60:61], s[70:71]
    v_pk_mul_f32 v[62:63], v[62:63], s[70:71]
    v_exp_f32 v56, v56
    v_exp_f32 v57, v57
    v_exp_f32 v58, v58
    v_exp_f32 v59, v59
    v_exp_f32 v60, v60
    v_exp_f32 v61, v61
    v_exp_f32 v62, v62
    v_exp_f32 v63, v63
    v_pk_add_f32 v[56:57], v[56:57], s[72:73]
    v_pk_add_f32 v[58:59], v[58:59], s[72:73]
    v_pk_add_f32 v[60:61], v[60:61], s[72:73]
    v_pk_add_f32 v[62:63], v[62:63], s[72:73]
    v_rcp_f32 v56, v56
    v_rcp_f32 v57, v57
    v_rcp_f32 v58, v58
    v_rcp_f32 v59, v59
    v_rcp_f32 v60, v60
    v_rcp_f32 v61, v61
    v_rcp_f32 v62, v62
    v_rcp_f32 v63, v63
    v_pk_mul_f32 v[56:57], v[56:57], v[120:121]
    v_pk_mul_f32 v[58:59], v[58:59], v[122:123]
    v_pk_mul_f32 v[60:61], v[60:61], v[124:125]
    v_pk_mul_f32 v[62:63], v[62:63], v[126:127]
    v_cvt_pk_bf16_f32 v188, v56, v57
    v_cvt_pk_bf16_f32 v189, v58, v59
    v_cvt_pk_bf16_f32 v190, v60, v61
    v_cvt_pk_bf16_f32 v191, v62, v63
    s_nop 1
    v_permlane32_swap_b32 v188, v190
    v_permlane32_swap_b32 v189, v191
    buffer_store_dwordx4 v[188:191], v209, s[56:59], s74 offen offset:3072 sc1
TB_end:
    s_endpgm
S1_aux:
    s_sub_u32 s67, s5, 30
    s_lshl_b32 s67, s67, 3
    s_add_u32 s67, s67, s4
    s_lshl_b32 s66, s67, 3
    s_add_u32 s66, s66, s3
    s_mov_b32 s44, s16
    s_mov_b32 s45, s17
    s_mov_b32 s46, 0x200000
    s_mov_b32 s47, 0x00020000
    s_mov_b32 s48, s34
    s_mov_b32 s49, s35
    s_mov_b32 s50, 0x400
    s_mov_b32 s51, 0x00020000
    s_mov_b32 s52, s40
    s_mov_b32 s53, s41
    s_mov_b32 s54, 0xdc2000
    s_mov_b32 s55, 0x00020000
    s_mov_b32 s96, s32
    s_mov_b32 s97, s33
    s_mov_b32 s98, 0x1c0000
    s_mov_b32 s99, 0x00020000
    s_bitcmp1_b32 s66, 3
    s_cselect_b32 s68, s24, s22
    s_cselect_b32 s69, s25, s23
    s_cselect_b32 s61, 0x80008000, 0
    s_mov_b32 s56, s68
    s_mov_b32 s57, s69
    s_mov_b32 s58, 0x80000
    s_mov_b32 s59, 0x00020000
    v_lshlrev_b32 v1, 2, v250
    s_mul_i32 s67, s66, 7
    s_add_u32 s70, s67, 0
    s_lshr_b32 s68, s70, 2
    s_and_b32 s69, s70, 3
    s_lshl_b32 s60, s68, 13
    s_lshl_b32 s63, s69, 8
    s_add_u32 s60, s60, s63
    s_add_u32 s63, s60, 4096
    buffer_load_dword v64, v1, s[96:99], s60 offen offset:0
    buffer_load_dword v65, v1, s[96:99], s60 offen offset:1024
    buffer_load_dword v66, v1, s[96:99], s60 offen offset:2048
    buffer_load_dword v67, v1, s[96:99], s60 offen offset:3072
    buffer_load_dword v68, v1, s[96:99], s63 offen offset:0
    buffer_load_dword v69, v1, s[96:99], s63 offen offset:1024
    buffer_load_dword v70, v1, s[96:99], s63 offen offset:2048
    buffer_load_dword v71, v1, s[96:99], s63 offen offset:3072
    s_add_u32 s70, s67, 1
    s_lshr_b32 s68, s70, 2
    s_and_b32 s69, s70, 3
    s_lshl_b32 s60, s68, 13
    s_lshl_b32 s63, s69, 8
    s_add_u32 s60, s60, s63
    s_add_u32 s63, s60, 4096
    buffer_load_dword v72, v1, s[96:99], s60 offen offset:0
    buffer_load_dword v73, v1, s[96:99], s60 offen offset:1024
    buffer_load_dword v74, v1, s[96:99], s60 offen offset:2048
    buffer_load_dword v75, v1, s[96:99], s60 offen offset:3072
    buffer_load_dword v76, v1, s[96:99], s63 offen offset:0
    buffer_load_dword v77, v1, s[96:99], s63 offen offset:1024
    buffer_load_dword v78, v1, s[96:99], s63 offen offset:2048
    buffer_load_dword v79, v1, s[96:99], s63 offen offset:3072
    s_add_u32 s70, s67, 2
    s_lshr_b32 s68, s70, 2
    s_and_b32 s69, s70, 3
    s_lshl_b32 s60, s68, 13
    s_lshl_b32 s63, s69, 8
    s_add_u32 s60, s60, s63
    s_add_u32 s63, s60, 4096
    buffer_load_dword v80, v1, s[96:99], s60 offen offset:0
    buffer_load_dword v81, v1, s[96:99], s60 offen offset:1024
    buffer_load_dword v82, v1, s[96:99], s60 offen offset:2048
    buffer_load_dword v83, v1, s[96:99], s60 offen offset:3072
    buffer_load_dword v84, v1, s[96:99], s63 offen offset:0
    buffer_load_dword v85, v1, s[96:99], s63 offen offset:1024
    buffer_load_dword v86, v1, s[96:99], s63 offen offset:2048
    buffer_load_dword v87, v1, s[96:99], s63 offen offset:3072
    s_add_u32 s70, s67, 3
    s_lshr_b32 s68, s70, 2
    s_and_b32 s69, s70, 3
    s_lshl_b32 s60, s68, 13
    s_lshl_b32 s63, s69, 8
    s_add_u32 s60, s60, s63
    s_add_u32 s63, s60, 4096
    buffer_load_dword v88, v1, s[96:99], s60 offen offset:0
    buffer_load_dword v89, v1, s[96:99], s60 offen offset:1024
    buffer_load_dword v90, v1, s[96:99], s60 offen offset:2048
    buffer_load_dword v91, v1, s[96:99], s60 offen offset:3072
    buffer_load_dword v92, v1, s[96:99], s63 offen offset:0
    buffer_load_dword v93, v1, s[96:99], s63 offen offset:1024
    buffer_load_dword v94, v1, s[96:99], s63 offen offset:2048
    buffer_load_dword v95, v1, s[96:99], s63 offen offset:3072
    s_add_u32 s70, s67, 4
    s_lshr_b32 s68, s70, 2
    s_and_b32 s69, s70, 3
    s_lshl_b32 s60, s68, 13
    s_lshl_b32 s63, s69, 8
    s_add_u32 s60, s60, s63
    s_add_u32 s63, s60, 4096
    buffer_load_dword v96, v1, s[96:99], s60 offen offset:0
    buffer_load_dword v97, v1, s[96:99], s60 offen offset:1024
    buffer_load_dword v98, v1, s[96:99], s60 offen offset:2048
    buffer_load_dword v99, v1, s[96:99], s60 offen offset:3072
    buffer_load_dword v100, v1, s[96:99], s63 offen offset:0
    buffer_load_dword v101, v1, s[96:99], s63 offen offset:1024
    buffer_load_dword v102, v1, s[96:99], s63 offen offset:2048
    buffer_load_dword v103, v1, s[96:99], s63 offen offset:3072
    s_add_u32 s70, s67, 5
    s_lshr_b32 s68, s70, 2
    s_and_b32 s69, s70, 3
    s_lshl_b32 s60, s68, 13
    s_lshl_b32 s63, s69, 8
    s_add_u32 s60, s60, s63
    s_add_u32 s63, s60, 4096
    buffer_load_dword v104, v1, s[96:99], s60 offen offset:0
    buffer_load_dword v105, v1, s[96:99], s60 offen offset:1024
    buffer_load_dword v106, v1, s[96:99], s60 offen offset:2048
    buffer_load_dword v107, v1, s[96:99], s60 offen offset:3072
    buffer_load_dword v108, v1, s[96:99], s63 offen offset:0
    buffer_load_dword v109, v1, s[96:99], s63 offen offset:1024
    buffer_load_dword v110, v1, s[96:99], s63 offen offset:2048
    buffer_load_dword v111, v1, s[96:99], s63 offen offset:3072
    s_add_u32 s70, s67, 6
    s_lshr_b32 s68, s70, 2
    s_and_b32 s69, s70, 3
    s_lshl_b32 s60, s68, 13
    s_lshl_b32 s63, s69, 8
    s_add_u32 s60, s60, s63
    s_add_u32 s63, s60, 4096
    buffer_load_dword v112, v1, s[96:99], s60 offen offset:0
    buffer_load_dword v113, v1, s[96:99], s60 offen offset:1024
    buffer_load_dword v114, v1, s[96:99], s60 offen offset:2048
    buffer_load_dword v115, v1, s[96:99], s60 offen offset:3072
    buffer_load_dword v116, v1, s[96:99], s63 offen offset:0
    buffer_load_dword v117, v1, s[96:99], s63 offen offset:1024
    buffer_load_dword v118, v1, s[96:99], s63 offen offset:2048
    buffer_load_dword v119, v1, s[96:99], s63 offen offset:3072
    s_lshr_b32 s67, s66, 4
    s_and_b32 s70, s66, 15
    v_and_b32 v5, 31, v250
    s_lshl_b32 s72, s67, 6
    v_add_u32 v5, s72, v5
    v_lshlrev_b32 v5, 10, v5
    v_lshrrev_b32 v6, 5, v250
    v_lshl_add_u32 v5, v6, 4, v5
    v_add_u32 v6, 32768, v5
    s_and_b32 s72, s70, 7
    s_lshl_b32 s72, s72, 7
    buffer_load_dwordx4 v[128:131], v5, s[56:59], s72 offen offset:0
    buffer_load_dwordx4 v[132:135], v6, s[56:59], s72 offen offset:0
    buffer_load_dwordx4 v[136:139], v5, s[56:59], s72 offen offset:32
    buffer_load_dwordx4 v[140:143], v6, s[56:59], s72 offen offset:32
    buffer_load_dwordx4 v[144:147], v5, s[56:59], s72 offen offset:64
    buffer_load_dwordx4 v[148:151], v6, s[56:59], s72 offen offset:64
    buffer_load_dwordx4 v[152:155], v5, s[56:59], s72 offen offset:96
    buffer_load_dwordx4 v[156:159], v6, s[56:59], s72 offen offset:96
    s_mul_i32 s62, s67, 360448
    s_lshl_b32 s70, s70, 13
    s_add_u32 s62, s62, s70
    s_add_u32 s62, s62, 0xb00000
    v_lshlrev_b32 v8, 4, v250
    s_lshl_b32 s63, s66, 14
    s_add_u32 s64, s63, 4096
    s_add_u32 s65, s63, 8192
    s_add_u32 s73, s63, 12288
    buffer_load_dwordx4 v[160:163], v8, s[44:47], s63 offen offset:0
    buffer_load_dwordx4 v[164:167], v8, s[44:47], s63 offen offset:1024
    buffer_load_dwordx4 v[168:171], v8, s[44:47], s63 offen offset:2048
    buffer_load_dwordx4 v[172:175], v8, s[44:47], s63 offen offset:3072
    buffer_load_dwordx4 v[176:179], v8, s[44:47], s64 offen offset:0
    buffer_load_dwordx4 v[180:183], v8, s[44:47], s64 offen offset:1024
    buffer_load_dwordx4 v[184:187], v8, s[44:47], s64 offen offset:2048
    buffer_load_dwordx4 v[188:191], v8, s[44:47], s64 offen offset:3072
    buffer_load_dwordx4 v[192:195], v8, s[44:47], s65 offen offset:0
    buffer_load_dwordx4 v[196:199], v8, s[44:47], s65 offen offset:1024
    buffer_load_dwordx4 v[200:203], v8, s[44:47], s65 offen offset:2048
    buffer_load_dwordx4 v[204:207], v8, s[44:47], s65 offen offset:3072
    buffer_load_dwordx4 v[208:211], v8, s[44:47], s73 offen offset:0
    buffer_load_dwordx4 v[212:215], v8, s[44:47], s73 offen offset:1024
    buffer_load_dwordx4 v[216:219], v8, s[44:47], s73 offen offset:2048
    buffer_load_dwordx4 v[220:223], v8, s[44:47], s73 offen offset:3072
    buffer_load_dwordx4 v[16:19], v8, s[48:51], 0 offen
    s_mov_b32 s71, 0x05040100
    s_mov_b32 s72, 0x07060302
    v_lshrrev_b32 v2, 5, v250
    v_mul_u32_u24 v2, 360448, v2
    v_bfe_u32 v3, v250, 4, 1
    v_lshl_add_u32 v2, v3, 10, v2
    v_and_b32 v3, 15, v250
    v_lshl_add_u32 v2, v3, 5, v2
    s_mul_i32 s67, s66, 7
    s_waitcnt vmcnt(25)
    s_add_u32 s70, s67, 0
    s_lshr_b32 s68, s70, 2
    s_and_b32 s69, s70, 3
    s_mul_i32 s60, s69, 720896
    s_lshr_b32 s63, s68, 1
    s_lshl_b32 s63, s63, 11
    s_add_u32 s60, s60, s63
    s_and_b32 s63, s68, 1
    s_lshl_b32 s63, s63, 9
    s_add_u32 s60, s60, s63
    s_add_u32 s60, s60, 0xb20000
    v_perm_b32 v10, v65, v64, s72
    v_perm_b32 v11, v67, v66, s72
    v_perm_b32 v12, v69, v68, s72
    v_perm_b32 v13, v71, v70, s72
    v_perm_b32 v64, v65, v64, s71
    v_perm_b32 v65, v67, v66, s71
    v_perm_b32 v66, v69, v68, s71
    v_perm_b32 v67, v71, v70, s71
    v_mov_b32 v68, v10
    v_mov_b32 v69, v11
    v_mov_b32 v70, v12
    v_mov_b32 v71, v13
    buffer_store_dwordx4 v[64:67], v2, s[52:55], s60 offen
    buffer_store_dwordx4 v[68:71], v2, s[52:55], s60 offen offset:16
    s_add_u32 s70, s67, 1
    s_lshr_b32 s68, s70, 2
    s_and_b32 s69, s70, 3
    s_mul_i32 s60, s69, 720896
    s_lshr_b32 s63, s68, 1
    s_lshl_b32 s63, s63, 11
    s_add_u32 s60, s60, s63
    s_and_b32 s63, s68, 1
    s_lshl_b32 s63, s63, 9
    s_add_u32 s60, s60, s63
    s_add_u32 s60, s60, 0xb20000
    v_perm_b32 v10, v73, v72, s72
    v_perm_b32 v11, v75, v74, s72
    v_perm_b32 v12, v77, v76, s72
    v_perm_b32 v13, v79, v78, s72
    v_perm_b32 v72, v73, v72, s71
    v_perm_b32 v73, v75, v74, s71
    v_perm_b32 v74, v77, v76, s71
    v_perm_b32 v75, v79, v78, s71
    v_mov_b32 v76, v10
    v_mov_b32 v77, v11
    v_mov_b32 v78, v12
    v_mov_b32 v79, v13
    buffer_store_dwordx4 v[72:75], v2, s[52:55], s60 offen
    buffer_store_dwordx4 v[76:79], v2, s[52:55], s60 offen offset:16
    s_add_u32 s70, s67, 2
    s_lshr_b32 s68, s70, 2
    s_and_b32 s69, s70, 3
    s_mul_i32 s60, s69, 720896
    s_lshr_b32 s63, s68, 1
    s_lshl_b32 s63, s63, 11
    s_add_u32 s60, s60, s63
    s_and_b32 s63, s68, 1
    s_lshl_b32 s63, s63, 9
    s_add_u32 s60, s60, s63
    s_add_u32 s60, s60, 0xb20000
    v_perm_b32 v10, v81, v80, s72
    v_perm_b32 v11, v83, v82, s72
    v_perm_b32 v12, v85, v84, s72
    v_perm_b32 v13, v87, v86, s72
    v_perm_b32 v80, v81, v80, s71
    v_perm_b32 v81, v83, v82, s71
    v_perm_b32 v82, v85, v84, s71
    v_perm_b32 v83, v87, v86, s71
    v_mov_b32 v84, v10
    v_mov_b32 v85, v11
    v_mov_b32 v86, v12
    v_mov_b32 v87, v13
    buffer_store_dwordx4 v[80:83], v2, s[52:55], s60 offen
    buffer_store_dwordx4 v[84:87], v2, s[52:55], s60 offen offset:16
    s_add_u32 s70, s67, 3
    s_lshr_b32 s68, s70, 2
    s_and_b32 s69, s70, 3
    s_mul_i32 s60, s69, 720896
    s_lshr_b32 s63, s68, 1
    s_lshl_b32 s63, s63, 11
    s_add_u32 s60, s60, s63
    s_and_b32 s63, s68, 1
    s_lshl_b32 s63, s63, 9
    s_add_u32 s60, s60, s63
    s_add_u32 s60, s60, 0xb20000
    v_perm_b32 v10, v89, v88, s72
    v_perm_b32 v11, v91, v90, s72
    v_perm_b32 v12, v93, v92, s72
    v_perm_b32 v13, v95, v94, s72
    v_perm_b32 v88, v89, v88, s71
    v_perm_b32 v89, v91, v90, s71
    v_perm_b32 v90, v93, v92, s71
    v_perm_b32 v91, v95, v94, s71
    v_mov_b32 v92, v10
    v_mov_b32 v93, v11
    v_mov_b32 v94, v12
    v_mov_b32 v95, v13
    buffer_store_dwordx4 v[88:91], v2, s[52:55], s60 offen
    buffer_store_dwordx4 v[92:95], v2, s[52:55], s60 offen offset:16
    s_add_u32 s70, s67, 4
    s_lshr_b32 s68, s70, 2
    s_and_b32 s69, s70, 3
    s_mul_i32 s60, s69, 720896
    s_lshr_b32 s63, s68, 1
    s_lshl_b32 s63, s63, 11
    s_add_u32 s60, s60, s63
    s_and_b32 s63, s68, 1
    s_lshl_b32 s63, s63, 9
    s_add_u32 s60, s60, s63
    s_add_u32 s60, s60, 0xb20000
    v_perm_b32 v10, v97, v96, s72
    v_perm_b32 v11, v99, v98, s72
    v_perm_b32 v12, v101, v100, s72
    v_perm_b32 v13, v103, v102, s72
    v_perm_b32 v96, v97, v96, s71
    v_perm_b32 v97, v99, v98, s71
    v_perm_b32 v98, v101, v100, s71
    v_perm_b32 v99, v103, v102, s71
    v_mov_b32 v100, v10
    v_mov_b32 v101, v11
    v_mov_b32 v102, v12
    v_mov_b32 v103, v13
    buffer_store_dwordx4 v[96:99], v2, s[52:55], s60 offen
    buffer_store_dwordx4 v[100:103], v2, s[52:55], s60 offen offset:16
    s_add_u32 s70, s67, 5
    s_lshr_b32 s68, s70, 2
    s_and_b32 s69, s70, 3
    s_mul_i32 s60, s69, 720896
    s_lshr_b32 s63, s68, 1
    s_lshl_b32 s63, s63, 11
    s_add_u32 s60, s60, s63
    s_and_b32 s63, s68, 1
    s_lshl_b32 s63, s63, 9
    s_add_u32 s60, s60, s63
    s_add_u32 s60, s60, 0xb20000
    v_perm_b32 v10, v105, v104, s72
    v_perm_b32 v11, v107, v106, s72
    v_perm_b32 v12, v109, v108, s72
    v_perm_b32 v13, v111, v110, s72
    v_perm_b32 v104, v105, v104, s71
    v_perm_b32 v105, v107, v106, s71
    v_perm_b32 v106, v109, v108, s71
    v_perm_b32 v107, v111, v110, s71
    v_mov_b32 v108, v10
    v_mov_b32 v109, v11
    v_mov_b32 v110, v12
    v_mov_b32 v111, v13
    buffer_store_dwordx4 v[104:107], v2, s[52:55], s60 offen
    buffer_store_dwordx4 v[108:111], v2, s[52:55], s60 offen offset:16
    s_add_u32 s70, s67, 6
    s_lshr_b32 s68, s70, 2
    s_and_b32 s69, s70, 3
    s_mul_i32 s60, s69, 720896
    s_lshr_b32 s63, s68, 1
    s_lshl_b32 s63, s63, 11
    s_add_u32 s60, s60, s63
    s_and_b32 s63, s68, 1
    s_lshl_b32 s63, s63, 9
    s_add_u32 s60, s60, s63
    s_add_u32 s60, s60, 0xb20000
    v_perm_b32 v10, v113, v112, s72
    v_perm_b32 v11, v115, v114, s72
    v_perm_b32 v12, v117, v116, s72
    v_perm_b32 v13, v119, v118, s72
    v_perm_b32 v112, v113, v112, s71
    v_perm_b32 v113, v115, v114, s71
    v_perm_b32 v114, v117, v116, s71
    v_perm_b32 v115, v119, v118, s71
    v_mov_b32 v116, v10
    v_mov_b32 v117, v11
    v_mov_b32 v118, v12
    v_mov_b32 v119, v13
    buffer_store_dwordx4 v[112:115], v2, s[52:55], s60 offen
    buffer_store_dwordx4 v[116:119], v2, s[52:55], s60 offen offset:16
    s_waitcnt vmcnt(31)
    v_lshlrev_b32 v3, 4, v250
    v_add_u32 v4, 4096, v3
    v_xor_b32 v128, s61, v128
    v_xor_b32 v129, s61, v129
    v_xor_b32 v130, s61, v130
    v_xor_b32 v131, s61, v131
    v_xor_b32 v132, s61, v132
    v_xor_b32 v133, s61, v133
    v_xor_b32 v134, s61, v134
    v_xor_b32 v135, s61, v135
    v_xor_b32 v136, s61, v136
    v_xor_b32 v137, s61, v137
    v_xor_b32 v138, s61, v138
    v_xor_b32 v139, s61, v139
    v_xor_b32 v140, s61, v140
    v_xor_b32 v141, s61, v141
    v_xor_b32 v142, s61, v142
    v_xor_b32 v143, s61, v143
    v_xor_b32 v144, s61, v144
    v_xor_b32 v145, s61, v145
    v_xor_b32 v146, s61, v146
    v_xor_b32 v147, s61, v147
    v_xor_b32 v148, s61, v148
    v_xor_b32 v149, s61, v149
    v_xor_b32 v150, s61, v150
    v_xor_b32 v151, s61, v151
    v_xor_b32 v152, s61, v152
    v_xor_b32 v153, s61, v153
    v_xor_b32 v154, s61, v154
    v_xor_b32 v155, s61, v155
    v_xor_b32 v156, s61, v156
    v_xor_b32 v157, s61, v157
    v_xor_b32 v158, s61, v158
    v_xor_b32 v159, s61, v159
    buffer_store_dwordx4 v[128:131], v3, s[52:55], s62 offen offset:0
    buffer_store_dwordx4 v[132:135], v3, s[52:55], s62 offen offset:1024
    buffer_store_dwordx4 v[136:139], v3, s[52:55], s62 offen offset:2048
    buffer_store_dwordx4 v[140:143], v3, s[52:55], s62 offen offset:3072
    buffer_store_dwordx4 v[144:147], v4, s[52:55], s62 offen offset:0
    buffer_store_dwordx4 v[148:151], v4, s[52:55], s62 offen offset:1024
    buffer_store_dwordx4 v[152:155], v4, s[52:55], s62 offen offset:2048
    buffer_store_dwordx4 v[156:159], v4, s[52:55], s62 offen offset:3072
    s_waitcnt vmcnt(22)
    v_mov_b32 v20, 0
    v_mov_b32 v21, 0
    v_mov_b32 v22, 0
    v_mov_b32 v23, 0
    v_mov_b32 v24, 0
    v_mov_b32 v25, 0
    v_mov_b32 v26, 0
    v_mov_b32 v27, 0
    v_mov_b32 v28, 0
    v_mov_b32 v29, 0
    v_mov_b32 v30, 0
    v_mov_b32 v31, 0
    v_mov_b32 v32, 0
    v_mov_b32 v33, 0
    v_mov_b32 v34, 0
    v_mov_b32 v35, 0
    v_dot2_f32_bf16 v20, v160, v16, v20
    v_dot2_f32_bf16 v21, v164, v16, v21
    v_dot2_f32_bf16 v22, v168, v16, v22
    v_dot2_f32_bf16 v23, v172, v16, v23
    v_dot2_f32_bf16 v24, v176, v16, v24
    v_dot2_f32_bf16 v25, v180, v16, v25
    v_dot2_f32_bf16 v26, v184, v16, v26
    v_dot2_f32_bf16 v27, v188, v16, v27
    v_dot2_f32_bf16 v28, v192, v16, v28
    v_dot2_f32_bf16 v29, v196, v16, v29
    v_dot2_f32_bf16 v30, v200, v16, v30
    v_dot2_f32_bf16 v31, v204, v16, v31
    v_dot2_f32_bf16 v32, v208, v16, v32
    v_dot2_f32_bf16 v33, v212, v16, v33
    v_dot2_f32_bf16 v34, v216, v16, v34
    v_dot2_f32_bf16 v35, v220, v16, v35
    v_dot2_f32_bf16 v20, v161, v17, v20
    v_dot2_f32_bf16 v21, v165, v17, v21
    v_dot2_f32_bf16 v22, v169, v17, v22
    v_dot2_f32_bf16 v23, v173, v17, v23
    v_dot2_f32_bf16 v24, v177, v17, v24
    v_dot2_f32_bf16 v25, v181, v17, v25
    v_dot2_f32_bf16 v26, v185, v17, v26
    v_dot2_f32_bf16 v27, v189, v17, v27
    v_dot2_f32_bf16 v28, v193, v17, v28
    v_dot2_f32_bf16 v29, v197, v17, v29
    v_dot2_f32_bf16 v30, v201, v17, v30
    v_dot2_f32_bf16 v31, v205, v17, v31
    v_dot2_f32_bf16 v32, v209, v17, v32
    v_dot2_f32_bf16 v33, v213, v17, v33
    v_dot2_f32_bf16 v34, v217, v17, v34
    v_dot2_f32_bf16 v35, v221, v17, v35
    v_dot2_f32_bf16 v20, v162, v18, v20
    v_dot2_f32_bf16 v21, v166, v18, v21
    v_dot2_f32_bf16 v22, v170, v18, v22
    v_dot2_f32_bf16 v23, v174, v18, v23
    v_dot2_f32_bf16 v24, v178, v18, v24
    v_dot2_f32_bf16 v25, v182, v18, v25
    v_dot2_f32_bf16 v26, v186, v18, v26
    v_dot2_f32_bf16 v27, v190, v18, v27
    v_dot2_f32_bf16 v28, v194, v18, v28
    v_dot2_f32_bf16 v29, v198, v18, v29
    v_dot2_f32_bf16 v30, v202, v18, v30
    v_dot2_f32_bf16 v31, v206, v18, v31
    v_dot2_f32_bf16 v32, v210, v18, v32
    v_dot2_f32_bf16 v33, v214, v18, v33
    v_dot2_f32_bf16 v34, v218, v18, v34
    v_dot2_f32_bf16 v35, v222, v18, v35
    v_dot2_f32_bf16 v20, v163, v19, v20
    v_dot2_f32_bf16 v21, v167, v19, v21
    v_dot2_f32_bf16 v22, v171, v19, v22
    v_dot2_f32_bf16 v23, v175, v19, v23
    v_dot2_f32_bf16 v24, v179, v19, v24
    v_dot2_f32_bf16 v25, v183, v19, v25
    v_dot2_f32_bf16 v26, v187, v19, v26
    v_dot2_f32_bf16 v27, v191, v19, v27
    v_dot2_f32_bf16 v28, v195, v19, v28
    v_dot2_f32_bf16 v29, v199, v19, v29
    v_dot2_f32_bf16 v30, v203, v19, v30
    v_dot2_f32_bf16 v31, v207, v19, v31
    v_dot2_f32_bf16 v32, v211, v19, v32
    v_dot2_f32_bf16 v33, v215, v19, v33
    v_dot2_f32_bf16 v34, v219, v19, v34
    v_dot2_f32_bf16 v35, v223, v19, v35
    s_mul_i32 s63, s3, 4352
    v_lshlrev_b32 v10, 2, v250
    v_add_u32 v10, s63, v10
    s_nop 1
    ds_write_b32 v10, v20 offset:0
    ds_write_b32 v10, v21 offset:272
    ds_write_b32 v10, v22 offset:544
    ds_write_b32 v10, v23 offset:816
    ds_write_b32 v10, v24 offset:1088
    ds_write_b32 v10, v25 offset:1360
    ds_write_b32 v10, v26 offset:1632
    ds_write_b32 v10, v27 offset:1904
    ds_write_b32 v10, v28 offset:2176
    ds_write_b32 v10, v29 offset:2448
    ds_write_b32 v10, v30 offset:2720
    ds_write_b32 v10, v31 offset:2992
    ds_write_b32 v10, v32 offset:3264
    ds_write_b32 v10, v33 offset:3536
    ds_write_b32 v10, v34 offset:3808
    ds_write_b32 v10, v35 offset:4080
    v_lshrrev_b32 v7, 2, v250
    v_mul_u32_u24 v11, 272, v7
    v_and_b32 v12, 3, v250
    v_lshl_add_u32 v11, v12, 6, v11
    v_add_u32 v11, s63, v11
    s_waitcnt lgkmcnt(0)
    ds_read_b128 v[36:39], v11 offset:0
    ds_read_b128 v[40:43], v11 offset:16
    ds_read_b128 v[44:47], v11 offset:32
    ds_read_b128 v[48:51], v11 offset:48
    s_waitcnt lgkmcnt(0)
    v_add_f32 v36, v36, v44
    v_add_f32 v37, v37, v45
    v_add_f32 v38, v38, v46
    v_add_f32 v39, v39, v47
    v_add_f32 v40, v40, v48
    v_add_f32 v41, v41, v49
    v_add_f32 v42, v42, v50
    v_add_f32 v43, v43, v51
    v_add_f32 v36, v36, v40
    v_add_f32 v37, v37, v41
    v_add_f32 v38, v38, v42
    v_add_f32 v39, v39, v43
    v_add_f32 v36, v36, v38
    v_add_f32 v37, v37, v39
    v_add_f32 v10, v36, v37
    s_nop 1
    v_add_f32 v10, v10, v10 quad_perm:[1,0,3,2] row_mask:0xf bank_mask:0xf
    s_nop 1
    v_add_f32 v10, v10, v10 quad_perm:[2,3,0,1] row_mask:0xf bank_mask:0xf
    v_mul_f32 v10, 0xbfb8aa3b, v10
    v_exp_f32 v10, v10
    s_nop 0
    v_add_f32 v10, 1.0, v10
    v_rcp_f32 v10, v10
    s_lshl_b32 s63, s66, 4
    v_add_u32 v7, s63, v7
    v_lshlrev_b32 v11, 2, v7
    v_add_u32 v11, 0xdc0000, v11
    buffer_store_dword v10, v11, s[52:55], 0 offen
    s_endpgm
S1_exit:
    s_endpgm
    .globl gmix_stage2_kernel
    .p2align 8
    .type gmix_stage2_kernel,@function
gmix_stage2_kernel:
    s_cmp_ge_u32 s2, 256
    s_cbranch_scc1 S2_exit
    s_load_dwordx2 s[4:5], s[0:1], 80
    s_load_dwordx2 s[6:7], s[0:1], 96
    v_lshrrev_b32 v1, 6, v0
    v_and_b32 v200, 63, v0
    v_readfirstlane_b32 s3, v1
    s_and_b32 s8, s2, 7
    s_lshr_b32 s9, s2, 3
    s_lshl_b32 s10, s8, 2
    s_lshr_b32 s11, s9, 3
    s_add_u32 s10, s10, s11
    s_and_b32 s11, s9, 7
    s_waitcnt lgkmcnt(0)
    s_mov_b32 s12, s6
    s_mov_b32 s13, s7
    s_mov_b32 s14, 0xb00000
    s_mov_b32 s15, 0x00020000
    s_add_u32 s16, s6, 0xb00000
    s_addc_u32 s17, s7, 0
    s_mov_b32 s18, 0x2c0000
    s_mov_b32 s19, 0x00020000
    s_add_u32 s20, s6, 0xdc0000
    s_addc_u32 s21, s7, 0
    s_mov_b32 s22, 0x2000
    s_mov_b32 s23, 0x00020000
    s_mov_b32 s24, s4
    s_mov_b32 s25, s5
    s_mov_b32 s26, 0x200000
    s_mov_b32 s27, 0x00020000
    v_lshlrev_b32 v201, 4, v200
    v_and_b32 v202, 31, v200
    s_lshl_b32 s28, s10, 6
    v_add_u32 v202, s28, v202
    v_lshlrev_b32 v202, 2, v202
    buffer_load_dword v204, v202, s[20:23], 0 offen
    buffer_load_dword v205, v202, s[20:23], 0 offen offset:128
    s_mul_i32 s28, s10, 360448
    s_mul_i32 s29, s11, 360448
    s_lshl_b32 s30, s3, 15
    s_mul_i32 s31, s3, 57344
    s_add_u32 s31, s31, 131072
    s_add_u32 s32, s28, s30
    s_add_u32 s33, s29, s30
    s_add_u32 s34, s28, s31
    s_add_u32 s35, s29, s31
    s_lshr_b32 s38, s9, 3
    s_mov_b32 s36, 0
    s_mov_b32 s37, 0
    s_add_u32 s42, s32, s36
    s_add_u32 s43, s33, s36
    buffer_load_dwordx4 a[0:3], v201, s[12:15], s42 offen
    buffer_load_dwordx4 a[4:7], v201, s[12:15], s42 offen offset:1024
    buffer_load_dwordx4 a[8:11], v201, s[16:19], s43 offen
    buffer_load_dwordx4 a[12:15], v201, s[16:19], s43 offen offset:1024
    s_add_u32 s36, s36, 2048
    s_cmp_eq_u32 s36, 32768
    s_cselect_b32 s36, 0, s36
    s_add_u32 s42, s32, s36
    s_add_u32 s43, s33, s36
    buffer_load_dwordx4 a[16:19], v201, s[12:15], s42 offen
    buffer_load_dwordx4 a[20:23], v201, s[12:15], s42 offen offset:1024
    buffer_load_dwordx4 a[24:27], v201, s[16:19], s43 offen
    buffer_load_dwordx4 a[28:31], v201, s[16:19], s43 offen offset:1024
    s_add_u32 s36, s36, 2048
    s_cmp_eq_u32 s36, 32768
    s_cselect_b32 s36, 0, s36
    s_add_u32 s42, s32, s36
    s_add_u32 s43, s33, s36
    buffer_load_dwordx4 a[32:35], v201, s[12:15], s42 offen
    buffer_load_dwordx4 a[36:39], v201, s[12:15], s42 offen offset:1024
    buffer_load_dwordx4 a[40:43], v201, s[16:19], s43 offen
    buffer_load_dwordx4 a[44:47], v201, s[16:19], s43 offen offset:1024
    s_add_u32 s36, s36, 2048
    s_cmp_eq_u32 s36, 32768
    s_cselect_b32 s36, 0, s36
    s_add_u32 s42, s32, s36
    s_add_u32 s43, s33, s36
    buffer_load_dwordx4 a[48:51], v201, s[12:15], s42 offen
    buffer_load_dwordx4 a[52:55], v201, s[12:15], s42 offen offset:1024
    buffer_load_dwordx4 a[56:59], v201, s[16:19], s43 offen
    buffer_load_dwordx4 a[60:63], v201, s[16:19], s43 offen offset:1024
    s_add_u32 s36, s36, 2048
    s_cmp_eq_u32 s36, 32768
    s_cselect_b32 s36, 0, s36
    s_add_u32 s42, s32, s36
    s_add_u32 s43, s33, s36
    buffer_load_dwordx4 a[64:67], v201, s[12:15], s42 offen
    buffer_load_dwordx4 a[68:71], v201, s[12:15], s42 offen offset:1024
    buffer_load_dwordx4 a[72:75], v201, s[16:19], s43 offen
    buffer_load_dwordx4 a[76:79], v201, s[16:19], s43 offen offset:1024
    s_add_u32 s36, s36, 2048
    s_cmp_eq_u32 s36, 32768
    s_cselect_b32 s36, 0, s36
    s_add_u32 s42, s32, s36
    s_add_u32 s43, s33, s36
    buffer_load_dwordx4 a[80:83], v201, s[12:15], s42 offen
    buffer_load_dwordx4 a[84:87], v201, s[12:15], s42 offen offset:1024
    buffer_load_dwordx4 a[88:91], v201, s[16:19], s43 offen
    buffer_load_dwordx4 a[92:95], v201, s[16:19], s43 offen offset:1024
    s_add_u32 s36, s36, 2048
    s_cmp_eq_u32 s36, 32768
    s_cselect_b32 s36, 0, s36
    s_add_u32 s42, s32, s36
    s_add_u32 s43, s33, s36
    buffer_load_dwordx4 a[96:99], v201, s[12:15], s42 offen
    buffer_load_dwordx4 a[100:103], v201, s[12:15], s42 offen offset:1024
    buffer_load_dwordx4 a[104:107], v201, s[16:19], s43 offen
    buffer_load_dwordx4 a[108:111], v201, s[16:19], s43 offen offset:1024
    s_add_u32 s36, s36, 2048
    s_cmp_eq_u32 s36, 32768
    s_cselect_b32 s36, 0, s36
    s_add_u32 s42, s32, s36
    s_add_u32 s43, s33, s36
    buffer_load_dwordx4 a[112:115], v201, s[12:15], s42 offen
    buffer_load_dwordx4 a[116:119], v201, s[12:15], s42 offen offset:1024
    buffer_load_dwordx4 a[120:123], v201, s[16:19], s43 offen
    buffer_load_dwordx4 a[124:127], v201, s[16:19], s43 offen offset:1024
    s_add_u32 s36, s36, 2048
    s_cmp_eq_u32 s36, 32768
    s_cselect_b32 s36, 0, s36
    v_mov_b32 v0, 0
    v_mov_b32 v1, 0
    v_mov_b32 v2, 0
    v_mov_b32 v3, 0
    v_mov_b32 v4, 0
    v_mov_b32 v5, 0
    v_mov_b32 v6, 0
    v_mov_b32 v7, 0
    v_mov_b32 v8, 0
    v_mov_b32 v9, 0
    v_mov_b32 v10, 0
    v_mov_b32 v11, 0
    v_mov_b32 v12, 0
    v_mov_b32 v13, 0
    v_mov_b32 v14, 0
    v_mov_b32 v15, 0
    v_mov_b32 v16, 0
    v_mov_b32 v17, 0
    v_mov_b32 v18, 0
    v_mov_b32 v19, 0
    v_mov_b32 v20, 0
    v_mov_b32 v21, 0
    v_mov_b32 v22, 0
    v_mov_b32 v23, 0
    v_mov_b32 v24, 0
    v_mov_b32 v25, 0
    v_mov_b32 v26, 0
    v_mov_b32 v27, 0
    v_mov_b32 v28, 0
    v_mov_b32 v29, 0
    v_mov_b32 v30, 0
    v_mov_b32 v31, 0
    v_mov_b32 v32, 0
    v_mov_b32 v33, 0
    v_mov_b32 v34, 0
    v_mov_b32 v35, 0
    v_mov_b32 v36, 0
    v_mov_b32 v37, 0
    v_mov_b32 v38, 0
    v_mov_b32 v39, 0
    v_mov_b32 v40, 0
    v_mov_b32 v41, 0
    v_mov_b32 v42, 0
    v_mov_b32 v43, 0
    v_mov_b32 v44, 0
    v_mov_b32 v45, 0
    v_mov_b32 v46, 0
    v_mov_b32 v47, 0
    v_mov_b32 v48, 0
    v_mov_b32 v49, 0
    v_mov_b32 v50, 0
    v_mov_b32 v51, 0
    v_mov_b32 v52, 0
    v_mov_b32 v53, 0
    v_mov_b32 v54, 0
    v_mov_b32 v55, 0
    v_mov_b32 v56, 0
    v_mov_b32 v57, 0
    v_mov_b32 v58, 0
    v_mov_b32 v59, 0
    v_mov_b32 v60, 0
    v_mov_b32 v61, 0
    v_mov_b32 v62, 0
    v_mov_b32 v63, 0
    v_mov_b32 v64, 0
    v_mov_b32 v65, 0
    v_mov_b32 v66, 0
    v_mov_b32 v67, 0
    v_mov_b32 v68, 0
    v_mov_b32 v69, 0
    v_mov_b32 v70, 0
    v_mov_b32 v71, 0
    v_mov_b32 v72, 0
    v_mov_b32 v73, 0
    v_mov_b32 v74, 0
    v_mov_b32 v75, 0
    v_mov_b32 v76, 0
    v_mov_b32 v77, 0
    v_mov_b32 v78, 0
    v_mov_b32 v79, 0
    v_mov_b32 v80, 0
    v_mov_b32 v81, 0
    v_mov_b32 v82, 0
    v_mov_b32 v83, 0
    v_mov_b32 v84, 0
    v_mov_b32 v85, 0
    v_mov_b32 v86, 0
    v_mov_b32 v87, 0
    v_mov_b32 v88, 0
    v_mov_b32 v89, 0
    v_mov_b32 v90, 0
    v_mov_b32 v91, 0
    v_mov_b32 v92, 0
    v_mov_b32 v93, 0
    v_mov_b32 v94, 0
    v_mov_b32 v95, 0
    v_mov_b32 v96, 0
    v_mov_b32 v97, 0
    v_mov_b32 v98, 0
    v_mov_b32 v99, 0
    v_mov_b32 v100, 0
    v_mov_b32 v101, 0
    v_mov_b32 v102, 0
    v_mov_b32 v103, 0
    v_mov_b32 v104, 0
    v_mov_b32 v105, 0
    v_mov_b32 v106, 0
    v_mov_b32 v107, 0
    v_mov_b32 v108, 0
    v_mov_b32 v109, 0
    v_mov_b32 v110, 0
    v_mov_b32 v111, 0
    v_mov_b32 v112, 0
    v_mov_b32 v113, 0
    v_mov_b32 v114, 0
    v_mov_b32 v115, 0
    v_mov_b32 v116, 0
    v_mov_b32 v117, 0
    v_mov_b32 v118, 0
    v_mov_b32 v119, 0
    v_mov_b32 v120, 0
    v_mov_b32 v121, 0
    v_mov_b32 v122, 0
    v_mov_b32 v123, 0
    v_mov_b32 v124, 0
    v_mov_b32 v125, 0
    v_mov_b32 v126, 0
    v_mov_b32 v127, 0
    s_waitcnt vmcnt(28)
    v_mfma_f32_32x32x16_bf16 v[0:15], a[8:11], a[0:3], v[0:15]
    v_mfma_f32_32x32x16_bf16 v[16:31], a[8:11], a[4:7], v[16:31]
    v_mfma_f32_32x32x16_bf16 v[32:47], a[12:15], a[0:3], v[32:47]
    v_mfma_f32_32x32x16_bf16 v[48:63], a[12:15], a[4:7], v[48:63]
    s_add_u32 s42, s32, s36
    s_add_u32 s43, s33, s36
    buffer_load_dwordx4 a[0:3], v201, s[12:15], s42 offen
    buffer_load_dwordx4 a[4:7], v201, s[12:15], s42 offen offset:1024
    buffer_load_dwordx4 a[8:11], v201, s[16:19], s43 offen
    buffer_load_dwordx4 a[12:15], v201, s[16:19], s43 offen offset:1024
    s_add_u32 s36, s36, 2048
    s_cmp_eq_u32 s36, 32768
    s_cselect_b32 s36, 0, s36
    s_waitcnt vmcnt(28)
    v_mfma_f32_32x32x16_bf16 v[0:15], a[24:27], a[16:19], v[0:15]
    v_mfma_f32_32x32x16_bf16 v[16:31], a[24:27], a[20:23], v[16:31]
    v_mfma_f32_32x32x16_bf16 v[32:47], a[28:31], a[16:19], v[32:47]
    v_mfma_f32_32x32x16_bf16 v[48:63], a[28:31], a[20:23], v[48:63]
    s_add_u32 s42, s32, s36
    s_add_u32 s43, s33, s36
    buffer_load_dwordx4 a[16:19], v201, s[12:15], s42 offen
    buffer_load_dwordx4 a[20:23], v201, s[12:15], s42 offen offset:1024
    buffer_load_dwordx4 a[24:27], v201, s[16:19], s43 offen
    buffer_load_dwordx4 a[28:31], v201, s[16:19], s43 offen offset:1024
    s_add_u32 s36, s36, 2048
    s_cmp_eq_u32 s36, 32768
    s_cselect_b32 s36, 0, s36
    s_waitcnt vmcnt(28)
    v_mfma_f32_32x32x16_bf16 v[0:15], a[40:43], a[32:35], v[0:15]
    v_mfma_f32_32x32x16_bf16 v[16:31], a[40:43], a[36:39], v[16:31]
    v_mfma_f32_32x32x16_bf16 v[32:47], a[44:47], a[32:35], v[32:47]
    v_mfma_f32_32x32x16_bf16 v[48:63], a[44:47], a[36:39], v[48:63]
    s_add_u32 s42, s32, s36
    s_add_u32 s43, s33, s36
    buffer_load_dwordx4 a[32:35], v201, s[12:15], s42 offen
    buffer_load_dwordx4 a[36:39], v201, s[12:15], s42 offen offset:1024
    buffer_load_dwordx4 a[40:43], v201, s[16:19], s43 offen
    buffer_load_dwordx4 a[44:47], v201, s[16:19], s43 offen offset:1024
    s_add_u32 s36, s36, 2048
    s_cmp_eq_u32 s36, 32768
    s_cselect_b32 s36, 0, s36
    s_waitcnt vmcnt(28)
    v_mfma_f32_32x32x16_bf16 v[0:15], a[56:59], a[48:51], v[0:15]
    v_mfma_f32_32x32x16_bf16 v[16:31], a[56:59], a[52:55], v[16:31]
    v_mfma_f32_32x32x16_bf16 v[32:47], a[60:63], a[48:51], v[32:47]
    v_mfma_f32_32x32x16_bf16 v[48:63], a[60:63], a[52:55], v[48:63]
    s_add_u32 s42, s32, s36
    s_add_u32 s43, s33, s36
    buffer_load_dwordx4 a[48:51], v201, s[12:15], s42 offen
    buffer_load_dwordx4 a[52:55], v201, s[12:15], s42 offen offset:1024
    buffer_load_dwordx4 a[56:59], v201, s[16:19], s43 offen
    buffer_load_dwordx4 a[60:63], v201, s[16:19], s43 offen offset:1024
    s_add_u32 s36, s36, 2048
    s_cmp_eq_u32 s36, 32768
    s_cselect_b32 s36, 0, s36
    s_waitcnt vmcnt(28)
    v_mfma_f32_32x32x16_bf16 v[0:15], a[72:75], a[64:67], v[0:15]
    v_mfma_f32_32x32x16_bf16 v[16:31], a[72:75], a[68:71], v[16:31]
    v_mfma_f32_32x32x16_bf16 v[32:47], a[76:79], a[64:67], v[32:47]
    v_mfma_f32_32x32x16_bf16 v[48:63], a[76:79], a[68:71], v[48:63]
    s_add_u32 s42, s32, s36
    s_add_u32 s43, s33, s36
    buffer_load_dwordx4 a[64:67], v201, s[12:15], s42 offen
    buffer_load_dwordx4 a[68:71], v201, s[12:15], s42 offen offset:1024
    buffer_load_dwordx4 a[72:75], v201, s[16:19], s43 offen
    buffer_load_dwordx4 a[76:79], v201, s[16:19], s43 offen offset:1024
    s_add_u32 s36, s36, 2048
    s_cmp_eq_u32 s36, 32768
    s_cselect_b32 s36, 0, s36
    s_waitcnt vmcnt(28)
    v_mfma_f32_32x32x16_bf16 v[0:15], a[88:91], a[80:83], v[0:15]
    v_mfma_f32_32x32x16_bf16 v[16:31], a[88:91], a[84:87], v[16:31]
    v_mfma_f32_32x32x16_bf16 v[32:47], a[92:95], a[80:83], v[32:47]
    v_mfma_f32_32x32x16_bf16 v[48:63], a[92:95], a[84:87], v[48:63]
    s_add_u32 s42, s32, s36
    s_add_u32 s43, s33, s36
    buffer_load_dwordx4 a[80:83], v201, s[12:15], s42 offen
    buffer_load_dwordx4 a[84:87], v201, s[12:15], s42 offen offset:1024
    buffer_load_dwordx4 a[88:91], v201, s[16:19], s43 offen
    buffer_load_dwordx4 a[92:95], v201, s[16:19], s43 offen offset:1024
    s_add_u32 s36, s36, 2048
    s_cmp_eq_u32 s36, 32768
    s_cselect_b32 s36, 0, s36
    s_waitcnt vmcnt(28)
    v_mfma_f32_32x32x16_bf16 v[0:15], a[104:107], a[96:99], v[0:15]
    v_mfma_f32_32x32x16_bf16 v[16:31], a[104:107], a[100:103], v[16:31]
    v_mfma_f32_32x32x16_bf16 v[32:47], a[108:111], a[96:99], v[32:47]
    v_mfma_f32_32x32x16_bf16 v[48:63], a[108:111], a[100:103], v[48:63]
    s_add_u32 s42, s32, s36
    s_add_u32 s43, s33, s36
    buffer_load_dwordx4 a[96:99], v201, s[12:15], s42 offen
    buffer_load_dwordx4 a[100:103], v201, s[12:15], s42 offen offset:1024
    buffer_load_dwordx4 a[104:107], v201, s[16:19], s43 offen
    buffer_load_dwordx4 a[108:111], v201, s[16:19], s43 offen offset:1024
    s_add_u32 s36, s36, 2048
    s_cmp_eq_u32 s36, 32768
    s_cselect_b32 s36, 0, s36
    s_waitcnt vmcnt(28)
    v_mfma_f32_32x32x16_bf16 v[0:15], a[120:123], a[112:115], v[0:15]
    v_mfma_f32_32x32x16_bf16 v[16:31], a[120:123], a[116:119], v[16:31]
    v_mfma_f32_32x32x16_bf16 v[32:47], a[124:127], a[112:115], v[32:47]
    v_mfma_f32_32x32x16_bf16 v[48:63], a[124:127], a[116:119], v[48:63]
    s_add_u32 s42, s32, s36
    s_add_u32 s43, s33, s36
    buffer_load_dwordx4 a[112:115], v201, s[12:15], s42 offen
    buffer_load_dwordx4 a[116:119], v201, s[12:15], s42 offen offset:1024
    buffer_load_dwordx4 a[120:123], v201, s[16:19], s43 offen
    buffer_load_dwordx4 a[124:127], v201, s[16:19], s43 offen offset:1024
    s_add_u32 s36, s36, 2048
    s_cmp_eq_u32 s36, 32768
    s_cselect_b32 s36, 0, s36
    s_waitcnt vmcnt(28)
    v_mfma_f32_32x32x16_bf16 v[0:15], a[8:11], a[0:3], v[0:15]
    v_mfma_f32_32x32x16_bf16 v[16:31], a[8:11], a[4:7], v[16:31]
    v_mfma_f32_32x32x16_bf16 v[32:47], a[12:15], a[0:3], v[32:47]
    v_mfma_f32_32x32x16_bf16 v[48:63], a[12:15], a[4:7], v[48:63]
    s_mov_b32 s32, s34
    s_mov_b32 s33, s35
    s_mov_b32 s36, s37
    s_add_u32 s42, s32, s36
    s_add_u32 s43, s33, s36
    buffer_load_dwordx4 a[0:3], v201, s[12:15], s42 offen
    buffer_load_dwordx4 a[4:7], v201, s[12:15], s42 offen offset:1024
    buffer_load_dwordx4 a[8:11], v201, s[16:19], s43 offen
    buffer_load_dwordx4 a[12:15], v201, s[16:19], s43 offen offset:1024
    s_add_u32 s36, s36, 2048
    s_cmp_eq_u32 s36, 57344
    s_cselect_b32 s36, 0, s36
    s_waitcnt vmcnt(28)
    v_mfma_f32_32x32x16_bf16 v[0:15], a[24:27], a[16:19], v[0:15]
    v_mfma_f32_32x32x16_bf16 v[16:31], a[24:27], a[20:23], v[16:31]
    v_mfma_f32_32x32x16_bf16 v[32:47], a[28:31], a[16:19], v[32:47]
    v_mfma_f32_32x32x16_bf16 v[48:63], a[28:31], a[20:23], v[48:63]
    s_add_u32 s42, s32, s36
    s_add_u32 s43, s33, s36
    buffer_load_dwordx4 a[16:19], v201, s[12:15], s42 offen
    buffer_load_dwordx4 a[20:23], v201, s[12:15], s42 offen offset:1024
    buffer_load_dwordx4 a[24:27], v201, s[16:19], s43 offen
    buffer_load_dwordx4 a[28:31], v201, s[16:19], s43 offen offset:1024
    s_add_u32 s36, s36, 2048
    s_cmp_eq_u32 s36, 57344
    s_cselect_b32 s36, 0, s36
    s_waitcnt vmcnt(28)
    v_mfma_f32_32x32x16_bf16 v[0:15], a[40:43], a[32:35], v[0:15]
    v_mfma_f32_32x32x16_bf16 v[16:31], a[40:43], a[36:39], v[16:31]
    v_mfma_f32_32x32x16_bf16 v[32:47], a[44:47], a[32:35], v[32:47]
    v_mfma_f32_32x32x16_bf16 v[48:63], a[44:47], a[36:39], v[48:63]
    s_add_u32 s42, s32, s36
    s_add_u32 s43, s33, s36
    buffer_load_dwordx4 a[32:35], v201, s[12:15], s42 offen
    buffer_load_dwordx4 a[36:39], v201, s[12:15], s42 offen offset:1024
    buffer_load_dwordx4 a[40:43], v201, s[16:19], s43 offen
    buffer_load_dwordx4 a[44:47], v201, s[16:19], s43 offen offset:1024
    s_add_u32 s36, s36, 2048
    s_cmp_eq_u32 s36, 57344
    s_cselect_b32 s36, 0, s36
    s_waitcnt vmcnt(28)
    v_mfma_f32_32x32x16_bf16 v[0:15], a[56:59], a[48:51], v[0:15]
    v_mfma_f32_32x32x16_bf16 v[16:31], a[56:59], a[52:55], v[16:31]
    v_mfma_f32_32x32x16_bf16 v[32:47], a[60:63], a[48:51], v[32:47]
    v_mfma_f32_32x32x16_bf16 v[48:63], a[60:63], a[52:55], v[48:63]
    s_add_u32 s42, s32, s36
    s_add_u32 s43, s33, s36
    buffer_load_dwordx4 a[48:51], v201, s[12:15], s42 offen
    buffer_load_dwordx4 a[52:55], v201, s[12:15], s42 offen offset:1024
    buffer_load_dwordx4 a[56:59], v201, s[16:19], s43 offen
    buffer_load_dwordx4 a[60:63], v201, s[16:19], s43 offen offset:1024
    s_add_u32 s36, s36, 2048
    s_cmp_eq_u32 s36, 57344
    s_cselect_b32 s36, 0, s36
    s_waitcnt vmcnt(28)
    v_mfma_f32_32x32x16_bf16 v[0:15], a[72:75], a[64:67], v[0:15]
    v_mfma_f32_32x32x16_bf16 v[16:31], a[72:75], a[68:71], v[16:31]
    v_mfma_f32_32x32x16_bf16 v[32:47], a[76:79], a[64:67], v[32:47]
    v_mfma_f32_32x32x16_bf16 v[48:63], a[76:79], a[68:71], v[48:63]
    s_add_u32 s42, s32, s36
    s_add_u32 s43, s33, s36
    buffer_load_dwordx4 a[64:67], v201, s[12:15], s42 offen
    buffer_load_dwordx4 a[68:71], v201, s[12:15], s42 offen offset:1024
    buffer_load_dwordx4 a[72:75], v201, s[16:19], s43 offen
    buffer_load_dwordx4 a[76:79], v201, s[16:19], s43 offen offset:1024
    s_add_u32 s36, s36, 2048
    s_cmp_eq_u32 s36, 57344
    s_cselect_b32 s36, 0, s36
    s_waitcnt vmcnt(28)
    v_mfma_f32_32x32x16_bf16 v[0:15], a[88:91], a[80:83], v[0:15]
    v_mfma_f32_32x32x16_bf16 v[16:31], a[88:91], a[84:87], v[16:31]
    v_mfma_f32_32x32x16_bf16 v[32:47], a[92:95], a[80:83], v[32:47]
    v_mfma_f32_32x32x16_bf16 v[48:63], a[92:95], a[84:87], v[48:63]
    s_add_u32 s42, s32, s36
    s_add_u32 s43, s33, s36
    buffer_load_dwordx4 a[80:83], v201, s[12:15], s42 offen
    buffer_load_dwordx4 a[84:87], v201, s[12:15], s42 offen offset:1024
    buffer_load_dwordx4 a[88:91], v201, s[16:19], s43 offen
    buffer_load_dwordx4 a[92:95], v201, s[16:19], s43 offen offset:1024
    s_add_u32 s36, s36, 2048
    s_cmp_eq_u32 s36, 57344
    s_cselect_b32 s36, 0, s36
    s_waitcnt vmcnt(28)
    v_mfma_f32_32x32x16_bf16 v[0:15], a[104:107], a[96:99], v[0:15]
    v_mfma_f32_32x32x16_bf16 v[16:31], a[104:107], a[100:103], v[16:31]
    v_mfma_f32_32x32x16_bf16 v[32:47], a[108:111], a[96:99], v[32:47]
    v_mfma_f32_32x32x16_bf16 v[48:63], a[108:111], a[100:103], v[48:63]
    s_add_u32 s42, s32, s36
    s_add_u32 s43, s33, s36
    buffer_load_dwordx4 a[96:99], v201, s[12:15], s42 offen
    buffer_load_dwordx4 a[100:103], v201, s[12:15], s42 offen offset:1024
    buffer_load_dwordx4 a[104:107], v201, s[16:19], s43 offen
    buffer_load_dwordx4 a[108:111], v201, s[16:19], s43 offen offset:1024
    s_add_u32 s36, s36, 2048
    s_cmp_eq_u32 s36, 57344
    s_cselect_b32 s36, 0, s36
    s_waitcnt vmcnt(28)
    v_mfma_f32_32x32x16_bf16 v[0:15], a[120:123], a[112:115], v[0:15]
    v_mfma_f32_32x32x16_bf16 v[16:31], a[120:123], a[116:119], v[16:31]
    v_mfma_f32_32x32x16_bf16 v[32:47], a[124:127], a[112:115], v[32:47]
    v_mfma_f32_32x32x16_bf16 v[48:63], a[124:127], a[116:119], v[48:63]
    s_add_u32 s42, s32, s36
    s_add_u32 s43, s33, s36
    buffer_load_dwordx4 a[112:115], v201, s[12:15], s42 offen
    buffer_load_dwordx4 a[116:119], v201, s[12:15], s42 offen offset:1024
    buffer_load_dwordx4 a[120:123], v201, s[16:19], s43 offen
    buffer_load_dwordx4 a[124:127], v201, s[16:19], s43 offen offset:1024
    s_add_u32 s36, s36, 2048
    s_cmp_eq_u32 s36, 57344
    s_cselect_b32 s36, 0, s36
    s_waitcnt vmcnt(28)
    v_mfma_f32_32x32x16_bf16 v[64:79], a[8:11], a[0:3], v[64:79]
    v_mfma_f32_32x32x16_bf16 v[80:95], a[8:11], a[4:7], v[80:95]
    v_mfma_f32_32x32x16_bf16 v[96:111], a[12:15], a[0:3], v[96:111]
    v_mfma_f32_32x32x16_bf16 v[112:127], a[12:15], a[4:7], v[112:127]
    s_add_u32 s42, s32, s36
    s_add_u32 s43, s33, s36
    buffer_load_dwordx4 a[0:3], v201, s[12:15], s42 offen
    buffer_load_dwordx4 a[4:7], v201, s[12:15], s42 offen offset:1024
    buffer_load_dwordx4 a[8:11], v201, s[16:19], s43 offen
    buffer_load_dwordx4 a[12:15], v201, s[16:19], s43 offen offset:1024
    s_add_u32 s36, s36, 2048
    s_cmp_eq_u32 s36, 57344
    s_cselect_b32 s36, 0, s36
    s_waitcnt vmcnt(28)
    v_mfma_f32_32x32x16_bf16 v[64:79], a[24:27], a[16:19], v[64:79]
    v_mfma_f32_32x32x16_bf16 v[80:95], a[24:27], a[20:23], v[80:95]
    v_mfma_f32_32x32x16_bf16 v[96:111], a[28:31], a[16:19], v[96:111]
    v_mfma_f32_32x32x16_bf16 v[112:127], a[28:31], a[20:23], v[112:127]
    s_add_u32 s42, s32, s36
    s_add_u32 s43, s33, s36
    buffer_load_dwordx4 a[16:19], v201, s[12:15], s42 offen
    buffer_load_dwordx4 a[20:23], v201, s[12:15], s42 offen offset:1024
    buffer_load_dwordx4 a[24:27], v201, s[16:19], s43 offen
    buffer_load_dwordx4 a[28:31], v201, s[16:19], s43 offen offset:1024
    s_add_u32 s36, s36, 2048
    s_cmp_eq_u32 s36, 57344
    s_cselect_b32 s36, 0, s36
    s_waitcnt vmcnt(28)
    v_mfma_f32_32x32x16_bf16 v[64:79], a[40:43], a[32:35], v[64:79]
    v_mfma_f32_32x32x16_bf16 v[80:95], a[40:43], a[36:39], v[80:95]
    v_mfma_f32_32x32x16_bf16 v[96:111], a[44:47], a[32:35], v[96:111]
    v_mfma_f32_32x32x16_bf16 v[112:127], a[44:47], a[36:39], v[112:127]
    s_add_u32 s42, s32, s36
    s_add_u32 s43, s33, s36
    buffer_load_dwordx4 a[32:35], v201, s[12:15], s42 offen
    buffer_load_dwordx4 a[36:39], v201, s[12:15], s42 offen offset:1024
    buffer_load_dwordx4 a[40:43], v201, s[16:19], s43 offen
    buffer_load_dwordx4 a[44:47], v201, s[16:19], s43 offen offset:1024
    s_add_u32 s36, s36, 2048
    s_cmp_eq_u32 s36, 57344
    s_cselect_b32 s36, 0, s36
    s_waitcnt vmcnt(28)
    v_mfma_f32_32x32x16_bf16 v[64:79], a[56:59], a[48:51], v[64:79]
    v_mfma_f32_32x32x16_bf16 v[80:95], a[56:59], a[52:55], v[80:95]
    v_mfma_f32_32x32x16_bf16 v[96:111], a[60:63], a[48:51], v[96:111]
    v_mfma_f32_32x32x16_bf16 v[112:127], a[60:63], a[52:55], v[112:127]
    s_add_u32 s42, s32, s36
    s_add_u32 s43, s33, s36
    buffer_load_dwordx4 a[48:51], v201, s[12:15], s42 offen
    buffer_load_dwordx4 a[52:55], v201, s[12:15], s42 offen offset:1024
    buffer_load_dwordx4 a[56:59], v201, s[16:19], s43 offen
    buffer_load_dwordx4 a[60:63], v201, s[16:19], s43 offen offset:1024
    s_add_u32 s36, s36, 2048
    s_cmp_eq_u32 s36, 57344
    s_cselect_b32 s36, 0, s36
    s_waitcnt vmcnt(28)
    v_mfma_f32_32x32x16_bf16 v[64:79], a[72:75], a[64:67], v[64:79]
    v_mfma_f32_32x32x16_bf16 v[80:95], a[72:75], a[68:71], v[80:95]
    v_mfma_f32_32x32x16_bf16 v[96:111], a[76:79], a[64:67], v[96:111]
    v_mfma_f32_32x32x16_bf16 v[112:127], a[76:79], a[68:71], v[112:127]
    s_add_u32 s42, s32, s36
    s_add_u32 s43, s33, s36
    buffer_load_dwordx4 a[64:67], v201, s[12:15], s42 offen
    buffer_load_dwordx4 a[68:71], v201, s[12:15], s42 offen offset:1024
    buffer_load_dwordx4 a[72:75], v201, s[16:19], s43 offen
    buffer_load_dwordx4 a[76:79], v201, s[16:19], s43 offen offset:1024
    s_add_u32 s36, s36, 2048
    s_cmp_eq_u32 s36, 57344
    s_cselect_b32 s36, 0, s36
    s_waitcnt vmcnt(28)
    v_mfma_f32_32x32x16_bf16 v[64:79], a[88:91], a[80:83], v[64:79]
    v_mfma_f32_32x32x16_bf16 v[80:95], a[88:91], a[84:87], v[80:95]
    v_mfma_f32_32x32x16_bf16 v[96:111], a[92:95], a[80:83], v[96:111]
    v_mfma_f32_32x32x16_bf16 v[112:127], a[92:95], a[84:87], v[112:127]
    s_add_u32 s42, s32, s36
    s_add_u32 s43, s33, s36
    buffer_load_dwordx4 a[80:83], v201, s[12:15], s42 offen
    buffer_load_dwordx4 a[84:87], v201, s[12:15], s42 offen offset:1024
    buffer_load_dwordx4 a[88:91], v201, s[16:19], s43 offen
    buffer_load_dwordx4 a[92:95], v201, s[16:19], s43 offen offset:1024
    s_add_u32 s36, s36, 2048
    s_cmp_eq_u32 s36, 57344
    s_cselect_b32 s36, 0, s36
    s_waitcnt vmcnt(28)
    v_mfma_f32_32x32x16_bf16 v[64:79], a[104:107], a[96:99], v[64:79]
    v_mfma_f32_32x32x16_bf16 v[80:95], a[104:107], a[100:103], v[80:95]
    v_mfma_f32_32x32x16_bf16 v[96:111], a[108:111], a[96:99], v[96:111]
    v_mfma_f32_32x32x16_bf16 v[112:127], a[108:111], a[100:103], v[112:127]
    s_add_u32 s42, s32, s36
    s_add_u32 s43, s33, s36
    buffer_load_dwordx4 a[96:99], v201, s[12:15], s42 offen
    buffer_load_dwordx4 a[100:103], v201, s[12:15], s42 offen offset:1024
    buffer_load_dwordx4 a[104:107], v201, s[16:19], s43 offen
    buffer_load_dwordx4 a[108:111], v201, s[16:19], s43 offen offset:1024
    s_add_u32 s36, s36, 2048
    s_cmp_eq_u32 s36, 57344
    s_cselect_b32 s36, 0, s36
    s_waitcnt vmcnt(28)
    v_mfma_f32_32x32x16_bf16 v[64:79], a[120:123], a[112:115], v[64:79]
    v_mfma_f32_32x32x16_bf16 v[80:95], a[120:123], a[116:119], v[80:95]
    v_mfma_f32_32x32x16_bf16 v[96:111], a[124:127], a[112:115], v[96:111]
    v_mfma_f32_32x32x16_bf16 v[112:127], a[124:127], a[116:119], v[112:127]
    s_add_u32 s42, s32, s36
    s_add_u32 s43, s33, s36
    buffer_load_dwordx4 a[112:115], v201, s[12:15], s42 offen
    buffer_load_dwordx4 a[116:119], v201, s[12:15], s42 offen offset:1024
    buffer_load_dwordx4 a[120:123], v201, s[16:19], s43 offen
    buffer_load_dwordx4 a[124:127], v201, s[16:19], s43 offen offset:1024
    s_add_u32 s36, s36, 2048
    s_cmp_eq_u32 s36, 57344
    s_cselect_b32 s36, 0, s36
    s_waitcnt vmcnt(28)
    v_mfma_f32_32x32x16_bf16 v[64:79], a[8:11], a[0:3], v[64:79]
    v_mfma_f32_32x32x16_bf16 v[80:95], a[8:11], a[4:7], v[80:95]
    v_mfma_f32_32x32x16_bf16 v[96:111], a[12:15], a[0:3], v[96:111]
    v_mfma_f32_32x32x16_bf16 v[112:127], a[12:15], a[4:7], v[112:127]
    s_add_u32 s42, s32, s36
    s_add_u32 s43, s33, s36
    buffer_load_dwordx4 a[0:3], v201, s[12:15], s42 offen
    buffer_load_dwordx4 a[4:7], v201, s[12:15], s42 offen offset:1024
    buffer_load_dwordx4 a[8:11], v201, s[16:19], s43 offen
    buffer_load_dwordx4 a[12:15], v201, s[16:19], s43 offen offset:1024
    s_add_u32 s36, s36, 2048
    s_cmp_eq_u32 s36, 57344
    s_cselect_b32 s36, 0, s36
    s_waitcnt vmcnt(28)
    v_mfma_f32_32x32x16_bf16 v[64:79], a[24:27], a[16:19], v[64:79]
    v_mfma_f32_32x32x16_bf16 v[80:95], a[24:27], a[20:23], v[80:95]
    v_mfma_f32_32x32x16_bf16 v[96:111], a[28:31], a[16:19], v[96:111]
    v_mfma_f32_32x32x16_bf16 v[112:127], a[28:31], a[20:23], v[112:127]
    s_add_u32 s42, s32, s36
    s_add_u32 s43, s33, s36
    buffer_load_dwordx4 a[16:19], v201, s[12:15], s42 offen
    buffer_load_dwordx4 a[20:23], v201, s[12:15], s42 offen offset:1024
    buffer_load_dwordx4 a[24:27], v201, s[16:19], s43 offen
    buffer_load_dwordx4 a[28:31], v201, s[16:19], s43 offen offset:1024
    s_add_u32 s36, s36, 2048
    s_cmp_eq_u32 s36, 57344
    s_cselect_b32 s36, 0, s36
    s_waitcnt vmcnt(28)
    v_mfma_f32_32x32x16_bf16 v[64:79], a[40:43], a[32:35], v[64:79]
    v_mfma_f32_32x32x16_bf16 v[80:95], a[40:43], a[36:39], v[80:95]
    v_mfma_f32_32x32x16_bf16 v[96:111], a[44:47], a[32:35], v[96:111]
    v_mfma_f32_32x32x16_bf16 v[112:127], a[44:47], a[36:39], v[112:127]
    s_add_u32 s42, s32, s36
    s_add_u32 s43, s33, s36
    buffer_load_dwordx4 a[32:35], v201, s[12:15], s42 offen
    buffer_load_dwordx4 a[36:39], v201, s[12:15], s42 offen offset:1024
    buffer_load_dwordx4 a[40:43], v201, s[16:19], s43 offen
    buffer_load_dwordx4 a[44:47], v201, s[16:19], s43 offen offset:1024
    s_add_u32 s36, s36, 2048
    s_cmp_eq_u32 s36, 57344
    s_cselect_b32 s36, 0, s36
    s_waitcnt vmcnt(28)
    v_mfma_f32_32x32x16_bf16 v[64:79], a[56:59], a[48:51], v[64:79]
    v_mfma_f32_32x32x16_bf16 v[80:95], a[56:59], a[52:55], v[80:95]
    v_mfma_f32_32x32x16_bf16 v[96:111], a[60:63], a[48:51], v[96:111]
    v_mfma_f32_32x32x16_bf16 v[112:127], a[60:63], a[52:55], v[112:127]
    s_add_u32 s42, s32, s36
    s_add_u32 s43, s33, s36
    buffer_load_dwordx4 a[48:51], v201, s[12:15], s42 offen
    buffer_load_dwordx4 a[52:55], v201, s[12:15], s42 offen offset:1024
    buffer_load_dwordx4 a[56:59], v201, s[16:19], s43 offen
    buffer_load_dwordx4 a[60:63], v201, s[16:19], s43 offen offset:1024
    s_add_u32 s36, s36, 2048
    s_cmp_eq_u32 s36, 57344
    s_cselect_b32 s36, 0, s36
    s_waitcnt vmcnt(28)
    v_mfma_f32_32x32x16_bf16 v[64:79], a[72:75], a[64:67], v[64:79]
    v_mfma_f32_32x32x16_bf16 v[80:95], a[72:75], a[68:71], v[80:95]
    v_mfma_f32_32x32x16_bf16 v[96:111], a[76:79], a[64:67], v[96:111]
    v_mfma_f32_32x32x16_bf16 v[112:127], a[76:79], a[68:71], v[112:127]
    s_add_u32 s42, s32, s36
    s_add_u32 s43, s33, s36
    buffer_load_dwordx4 a[64:67], v201, s[12:15], s42 offen
    buffer_load_dwordx4 a[68:71], v201, s[12:15], s42 offen offset:1024
    buffer_load_dwordx4 a[72:75], v201, s[16:19], s43 offen
    buffer_load_dwordx4 a[76:79], v201, s[16:19], s43 offen offset:1024
    s_add_u32 s36, s36, 2048
    s_cmp_eq_u32 s36, 57344
    s_cselect_b32 s36, 0, s36
    s_waitcnt vmcnt(28)
    v_mfma_f32_32x32x16_bf16 v[64:79], a[88:91], a[80:83], v[64:79]
    v_mfma_f32_32x32x16_bf16 v[80:95], a[88:91], a[84:87], v[80:95]
    v_mfma_f32_32x32x16_bf16 v[96:111], a[92:95], a[80:83], v[96:111]
    v_mfma_f32_32x32x16_bf16 v[112:127], a[92:95], a[84:87], v[112:127]
    s_add_u32 s42, s32, s36
    s_add_u32 s43, s33, s36
    buffer_load_dwordx4 a[80:83], v201, s[12:15], s42 offen
    buffer_load_dwordx4 a[84:87], v201, s[12:15], s42 offen offset:1024
    buffer_load_dwordx4 a[88:91], v201, s[16:19], s43 offen
    buffer_load_dwordx4 a[92:95], v201, s[16:19], s43 offen offset:1024
    s_add_u32 s36, s36, 2048
    s_cmp_eq_u32 s36, 57344
    s_cselect_b32 s36, 0, s36
    s_waitcnt vmcnt(28)
    v_mfma_f32_32x32x16_bf16 v[64:79], a[104:107], a[96:99], v[64:79]
    v_mfma_f32_32x32x16_bf16 v[80:95], a[104:107], a[100:103], v[80:95]
    v_mfma_f32_32x32x16_bf16 v[96:111], a[108:111], a[96:99], v[96:111]
    v_mfma_f32_32x32x16_bf16 v[112:127], a[108:111], a[100:103], v[112:127]
    s_add_u32 s42, s32, s36
    s_add_u32 s43, s33, s36
    buffer_load_dwordx4 a[96:99], v201, s[12:15], s42 offen
    buffer_load_dwordx4 a[100:103], v201, s[12:15], s42 offen offset:1024
    buffer_load_dwordx4 a[104:107], v201, s[16:19], s43 offen
    buffer_load_dwordx4 a[108:111], v201, s[16:19], s43 offen offset:1024
    s_add_u32 s36, s36, 2048
    s_cmp_eq_u32 s36, 57344
    s_cselect_b32 s36, 0, s36
    s_waitcnt vmcnt(28)
    v_mfma_f32_32x32x16_bf16 v[64:79], a[120:123], a[112:115], v[64:79]
    v_mfma_f32_32x32x16_bf16 v[80:95], a[120:123], a[116:119], v[80:95]
    v_mfma_f32_32x32x16_bf16 v[96:111], a[124:127], a[112:115], v[96:111]
    v_mfma_f32_32x32x16_bf16 v[112:127], a[124:127], a[116:119], v[112:127]
    s_add_u32 s42, s32, s36
    s_add_u32 s43, s33, s36
    buffer_load_dwordx4 a[112:115], v201, s[12:15], s42 offen
    buffer_load_dwordx4 a[116:119], v201, s[12:15], s42 offen offset:1024
    buffer_load_dwordx4 a[120:123], v201, s[16:19], s43 offen
    buffer_load_dwordx4 a[124:127], v201, s[16:19], s43 offen offset:1024
    s_add_u32 s36, s36, 2048
    s_cmp_eq_u32 s36, 57344
    s_cselect_b32 s36, 0, s36
    s_waitcnt vmcnt(28)
    v_mfma_f32_32x32x16_bf16 v[64:79], a[8:11], a[0:3], v[64:79]
    v_mfma_f32_32x32x16_bf16 v[80:95], a[8:11], a[4:7], v[80:95]
    v_mfma_f32_32x32x16_bf16 v[96:111], a[12:15], a[0:3], v[96:111]
    v_mfma_f32_32x32x16_bf16 v[112:127], a[12:15], a[4:7], v[112:127]
    s_add_u32 s42, s32, s36
    s_add_u32 s43, s33, s36
    buffer_load_dwordx4 a[0:3], v201, s[12:15], s42 offen
    buffer_load_dwordx4 a[4:7], v201, s[12:15], s42 offen offset:1024
    buffer_load_dwordx4 a[8:11], v201, s[16:19], s43 offen
    buffer_load_dwordx4 a[12:15], v201, s[16:19], s43 offen offset:1024
    s_add_u32 s36, s36, 2048
    s_cmp_eq_u32 s36, 57344
    s_cselect_b32 s36, 0, s36
    s_waitcnt vmcnt(28)
    v_mfma_f32_32x32x16_bf16 v[64:79], a[24:27], a[16:19], v[64:79]
    v_mfma_f32_32x32x16_bf16 v[80:95], a[24:27], a[20:23], v[80:95]
    v_mfma_f32_32x32x16_bf16 v[96:111], a[28:31], a[16:19], v[96:111]
    v_mfma_f32_32x32x16_bf16 v[112:127], a[28:31], a[20:23], v[112:127]
    s_add_u32 s42, s32, s36
    s_add_u32 s43, s33, s36
    buffer_load_dwordx4 a[16:19], v201, s[12:15], s42 offen
    buffer_load_dwordx4 a[20:23], v201, s[12:15], s42 offen offset:1024
    buffer_load_dwordx4 a[24:27], v201, s[16:19], s43 offen
    buffer_load_dwordx4 a[28:31], v201, s[16:19], s43 offen offset:1024
    s_add_u32 s36, s36, 2048
    s_cmp_eq_u32 s36, 57344
    s_cselect_b32 s36, 0, s36
    s_waitcnt vmcnt(28)
    v_mfma_f32_32x32x16_bf16 v[64:79], a[40:43], a[32:35], v[64:79]
    v_mfma_f32_32x32x16_bf16 v[80:95], a[40:43], a[36:39], v[80:95]
    v_mfma_f32_32x32x16_bf16 v[96:111], a[44:47], a[32:35], v[96:111]
    v_mfma_f32_32x32x16_bf16 v[112:127], a[44:47], a[36:39], v[112:127]
    s_add_u32 s42, s32, s36
    s_add_u32 s43, s33, s36
    buffer_load_dwordx4 a[32:35], v201, s[12:15], s42 offen
    buffer_load_dwordx4 a[36:39], v201, s[12:15], s42 offen offset:1024
    buffer_load_dwordx4 a[40:43], v201, s[16:19], s43 offen
    buffer_load_dwordx4 a[44:47], v201, s[16:19], s43 offen offset:1024
    s_add_u32 s36, s36, 2048
    s_cmp_eq_u32 s36, 57344
    s_cselect_b32 s36, 0, s36
    s_waitcnt vmcnt(28)
    v_mfma_f32_32x32x16_bf16 v[64:79], a[56:59], a[48:51], v[64:79]
    v_mfma_f32_32x32x16_bf16 v[80:95], a[56:59], a[52:55], v[80:95]
    v_mfma_f32_32x32x16_bf16 v[96:111], a[60:63], a[48:51], v[96:111]
    v_mfma_f32_32x32x16_bf16 v[112:127], a[60:63], a[52:55], v[112:127]
    s_add_u32 s42, s32, s36
    s_add_u32 s43, s33, s36
    buffer_load_dwordx4 a[48:51], v201, s[12:15], s42 offen
    buffer_load_dwordx4 a[52:55], v201, s[12:15], s42 offen offset:1024
    buffer_load_dwordx4 a[56:59], v201, s[16:19], s43 offen
    buffer_load_dwordx4 a[60:63], v201, s[16:19], s43 offen offset:1024
    s_add_u32 s36, s36, 2048
    s_cmp_eq_u32 s36, 57344
    s_cselect_b32 s36, 0, s36
    s_waitcnt vmcnt(28)
    v_mfma_f32_32x32x16_bf16 v[64:79], a[72:75], a[64:67], v[64:79]
    v_mfma_f32_32x32x16_bf16 v[80:95], a[72:75], a[68:71], v[80:95]
    v_mfma_f32_32x32x16_bf16 v[96:111], a[76:79], a[64:67], v[96:111]
    v_mfma_f32_32x32x16_bf16 v[112:127], a[76:79], a[68:71], v[112:127]
    s_waitcnt vmcnt(24)
    v_mfma_f32_32x32x16_bf16 v[64:79], a[88:91], a[80:83], v[64:79]
    v_mfma_f32_32x32x16_bf16 v[80:95], a[88:91], a[84:87], v[80:95]
    v_mfma_f32_32x32x16_bf16 v[96:111], a[92:95], a[80:83], v[96:111]
    v_mfma_f32_32x32x16_bf16 v[112:127], a[92:95], a[84:87], v[112:127]
    s_waitcnt vmcnt(20)
    v_mfma_f32_32x32x16_bf16 v[64:79], a[104:107], a[96:99], v[64:79]
    v_mfma_f32_32x32x16_bf16 v[80:95], a[104:107], a[100:103], v[80:95]
    v_mfma_f32_32x32x16_bf16 v[96:111], a[108:111], a[96:99], v[96:111]
    v_mfma_f32_32x32x16_bf16 v[112:127], a[108:111], a[100:103], v[112:127]
    s_waitcnt vmcnt(16)
    v_mfma_f32_32x32x16_bf16 v[64:79], a[120:123], a[112:115], v[64:79]
    v_mfma_f32_32x32x16_bf16 v[80:95], a[120:123], a[116:119], v[80:95]
    v_mfma_f32_32x32x16_bf16 v[96:111], a[124:127], a[112:115], v[96:111]
    v_mfma_f32_32x32x16_bf16 v[112:127], a[124:127], a[116:119], v[112:127]
    s_waitcnt vmcnt(12)
    v_mfma_f32_32x32x16_bf16 v[64:79], a[8:11], a[0:3], v[64:79]
    v_mfma_f32_32x32x16_bf16 v[80:95], a[8:11], a[4:7], v[80:95]
    v_mfma_f32_32x32x16_bf16 v[96:111], a[12:15], a[0:3], v[96:111]
    v_mfma_f32_32x32x16_bf16 v[112:127], a[12:15], a[4:7], v[112:127]
    s_waitcnt vmcnt(8)
    v_mfma_f32_32x32x16_bf16 v[64:79], a[24:27], a[16:19], v[64:79]
    v_mfma_f32_32x32x16_bf16 v[80:95], a[24:27], a[20:23], v[80:95]
    v_mfma_f32_32x32x16_bf16 v[96:111], a[28:31], a[16:19], v[96:111]
    v_mfma_f32_32x32x16_bf16 v[112:127], a[28:31], a[20:23], v[112:127]
    s_waitcnt vmcnt(4)
    v_mfma_f32_32x32x16_bf16 v[64:79], a[40:43], a[32:35], v[64:79]
    v_mfma_f32_32x32x16_bf16 v[80:95], a[40:43], a[36:39], v[80:95]
    v_mfma_f32_32x32x16_bf16 v[96:111], a[44:47], a[32:35], v[96:111]
    v_mfma_f32_32x32x16_bf16 v[112:127], a[44:47], a[36:39], v[112:127]
    s_waitcnt vmcnt(0)
    v_mfma_f32_32x32x16_bf16 v[64:79], a[56:59], a[48:51], v[64:79]
    v_mfma_f32_32x32x16_bf16 v[80:95], a[56:59], a[52:55], v[80:95]
    v_mfma_f32_32x32x16_bf16 v[96:111], a[60:63], a[48:51], v[96:111]
    v_mfma_f32_32x32x16_bf16 v[112:127], a[60:63], a[52:55], v[112:127]
    s_nop 15
    s_nop 3
    v_sub_f32 v0, v0, v64
    v_fma_f32 v0, v0, v204, v64
    v_sub_f32 v1, v1, v65
    v_fma_f32 v1, v1, v204, v65
    v_sub_f32 v2, v2, v66
    v_fma_f32 v2, v2, v204, v66
    v_sub_f32 v3, v3, v67
    v_fma_f32 v3, v3, v204, v67
    v_sub_f32 v4, v4, v68
    v_fma_f32 v4, v4, v204, v68
    v_sub_f32 v5, v5, v69
    v_fma_f32 v5, v5, v204, v69
    v_sub_f32 v6, v6, v70
    v_fma_f32 v6, v6, v204, v70
    v_sub_f32 v7, v7, v71
    v_fma_f32 v7, v7, v204, v71
    v_sub_f32 v8, v8, v72
    v_fma_f32 v8, v8, v204, v72
    v_sub_f32 v9, v9, v73
    v_fma_f32 v9, v9, v204, v73
    v_sub_f32 v10, v10, v74
    v_fma_f32 v10, v10, v204, v74
    v_sub_f32 v11, v11, v75
    v_fma_f32 v11, v11, v204, v75
    v_sub_f32 v12, v12, v76
    v_fma_f32 v12, v12, v204, v76
    v_sub_f32 v13, v13, v77
    v_fma_f32 v13, v13, v204, v77
    v_sub_f32 v14, v14, v78
    v_fma_f32 v14, v14, v204, v78
    v_sub_f32 v15, v15, v79
    v_fma_f32 v15, v15, v204, v79
    v_sub_f32 v16, v16, v80
    v_fma_f32 v16, v16, v205, v80
    v_sub_f32 v17, v17, v81
    v_fma_f32 v17, v17, v205, v81
    v_sub_f32 v18, v18, v82
    v_fma_f32 v18, v18, v205, v82
    v_sub_f32 v19, v19, v83
    v_fma_f32 v19, v19, v205, v83
    v_sub_f32 v20, v20, v84
    v_fma_f32 v20, v20, v205, v84
    v_sub_f32 v21, v21, v85
    v_fma_f32 v21, v21, v205, v85
    v_sub_f32 v22, v22, v86
    v_fma_f32 v22, v22, v205, v86
    v_sub_f32 v23, v23, v87
    v_fma_f32 v23, v23, v205, v87
    v_sub_f32 v24, v24, v88
    v_fma_f32 v24, v24, v205, v88
    v_sub_f32 v25, v25, v89
    v_fma_f32 v25, v25, v205, v89
    v_sub_f32 v26, v26, v90
    v_fma_f32 v26, v26, v205, v90
    v_sub_f32 v27, v27, v91
    v_fma_f32 v27, v27, v205, v91
    v_sub_f32 v28, v28, v92
    v_fma_f32 v28, v28, v205, v92
    v_sub_f32 v29, v29, v93
    v_fma_f32 v29, v29, v205, v93
    v_sub_f32 v30, v30, v94
    v_fma_f32 v30, v30, v205, v94
    v_sub_f32 v31, v31, v95
    v_fma_f32 v31, v31, v205, v95
    v_sub_f32 v32, v32, v96
    v_fma_f32 v32, v32, v204, v96
    v_sub_f32 v33, v33, v97
    v_fma_f32 v33, v33, v204, v97
    v_sub_f32 v34, v34, v98
    v_fma_f32 v34, v34, v204, v98
    v_sub_f32 v35, v35, v99
    v_fma_f32 v35, v35, v204, v99
    v_sub_f32 v36, v36, v100
    v_fma_f32 v36, v36, v204, v100
    v_sub_f32 v37, v37, v101
    v_fma_f32 v37, v37, v204, v101
    v_sub_f32 v38, v38, v102
    v_fma_f32 v38, v38, v204, v102
    v_sub_f32 v39, v39, v103
    v_fma_f32 v39, v39, v204, v103
    v_sub_f32 v40, v40, v104
    v_fma_f32 v40, v40, v204, v104
    v_sub_f32 v41, v41, v105
    v_fma_f32 v41, v41, v204, v105
    v_sub_f32 v42, v42, v106
    v_fma_f32 v42, v42, v204, v106
    v_sub_f32 v43, v43, v107
    v_fma_f32 v43, v43, v204, v107
    v_sub_f32 v44, v44, v108
    v_fma_f32 v44, v44, v204, v108
    v_sub_f32 v45, v45, v109
    v_fma_f32 v45, v45, v204, v109
    v_sub_f32 v46, v46, v110
    v_fma_f32 v46, v46, v204, v110
    v_sub_f32 v47, v47, v111
    v_fma_f32 v47, v47, v204, v111
    v_sub_f32 v48, v48, v112
    v_fma_f32 v48, v48, v205, v112
    v_sub_f32 v49, v49, v113
    v_fma_f32 v49, v49, v205, v113
    v_sub_f32 v50, v50, v114
    v_fma_f32 v50, v50, v205, v114
    v_sub_f32 v51, v51, v115
    v_fma_f32 v51, v51, v205, v115
    v_sub_f32 v52, v52, v116
    v_fma_f32 v52, v52, v205, v116
    v_sub_f32 v53, v53, v117
    v_fma_f32 v53, v53, v205, v117
    v_sub_f32 v54, v54, v118
    v_fma_f32 v54, v54, v205, v118
    v_sub_f32 v55, v55, v119
    v_fma_f32 v55, v55, v205, v119
    v_sub_f32 v56, v56, v120
    v_fma_f32 v56, v56, v205, v120
    v_sub_f32 v57, v57, v121
    v_fma_f32 v57, v57, v205, v121
    v_sub_f32 v58, v58, v122
    v_fma_f32 v58, v58, v205, v122
    v_sub_f32 v59, v59, v123
    v_fma_f32 v59, v59, v205, v123
    v_sub_f32 v60, v60, v124
    v_fma_f32 v60, v60, v205, v124
    v_sub_f32 v61, v61, v125
    v_fma_f32 v61, v61, v205, v125
    v_sub_f32 v62, v62, v126
    v_fma_f32 v62, v62, v205, v126
    v_sub_f32 v63, v63, v127
    v_fma_f32 v63, v63, v205, v127
    v_and_b32 v202, 31, v200
    v_mul_u32_u24 v202, 272, v202
    v_lshrrev_b32 v203, 5, v200
    v_lshl_add_u32 v202, v203, 4, v202
    s_mul_i32 s28, s3, 17408
    v_add_u32 v202, s28, v202
    ds_write_b128 v202, v[0:3] offset:0
    ds_write_b128 v202, v[4:7] offset:32
    ds_write_b128 v202, v[8:11] offset:64
    ds_write_b128 v202, v[12:15] offset:96
    ds_write_b128 v202, v[16:19] offset:8704
    ds_write_b128 v202, v[20:23] offset:8736
    ds_write_b128 v202, v[24:27] offset:8768
    ds_write_b128 v202, v[28:31] offset:8800
    ds_write_b128 v202, v[32:35] offset:128
    ds_write_b128 v202, v[36:39] offset:160
    ds_write_b128 v202, v[40:43] offset:192
    ds_write_b128 v202, v[44:47] offset:224
    ds_write_b128 v202, v[48:51] offset:8832
    ds_write_b128 v202, v[52:55] offset:8864
    ds_write_b128 v202, v[56:59] offset:8896
    ds_write_b128 v202, v[60:63] offset:8928
    s_waitcnt lgkmcnt(0)
    s_barrier
    s_lshl_b32 s28, s3, 6
    v_add_u32 v203, s28, v200
    v_lshrrev_b32 v206, 2, v203
    v_and_b32 v207, 3, v203
    v_mul_u32_u24 v208, 272, v206
    v_lshl_add_u32 v208, v207, 6, v208
    ds_read_b128 v[0:3], v208 offset:0
    ds_read_b128 v[4:7], v208 offset:16
    ds_read_b128 v[8:11], v208 offset:32
    ds_read_b128 v[12:15], v208 offset:48
    ds_read_b128 v[16:19], v208 offset:17408
    ds_read_b128 v[20:23], v208 offset:17424
    ds_read_b128 v[24:27], v208 offset:17440
    ds_read_b128 v[28:31], v208 offset:17456
    ds_read_b128 v[32:35], v208 offset:34816
    ds_read_b128 v[36:39], v208 offset:34832
    ds_read_b128 v[40:43], v208 offset:34848
    ds_read_b128 v[44:47], v208 offset:34864
    ds_read_b128 v[48:51], v208 offset:52224
    ds_read_b128 v[52:55], v208 offset:52240
    ds_read_b128 v[56:59], v208 offset:52256
    ds_read_b128 v[60:63], v208 offset:52272
    s_waitcnt lgkmcnt(0)
    v_add_f32 v0, v0, v16
    v_add_f32 v32, v32, v48
    v_add_f32 v1, v1, v17
    v_add_f32 v33, v33, v49
    v_add_f32 v2, v2, v18
    v_add_f32 v34, v34, v50
    v_add_f32 v3, v3, v19
    v_add_f32 v35, v35, v51
    v_add_f32 v4, v4, v20
    v_add_f32 v36, v36, v52
    v_add_f32 v5, v5, v21
    v_add_f32 v37, v37, v53
    v_add_f32 v6, v6, v22
    v_add_f32 v38, v38, v54
    v_add_f32 v7, v7, v23
    v_add_f32 v39, v39, v55
    v_add_f32 v8, v8, v24
    v_add_f32 v40, v40, v56
    v_add_f32 v9, v9, v25
    v_add_f32 v41, v41, v57
    v_add_f32 v10, v10, v26
    v_add_f32 v42, v42, v58
    v_add_f32 v11, v11, v27
    v_add_f32 v43, v43, v59
    v_add_f32 v12, v12, v28
    v_add_f32 v44, v44, v60
    v_add_f32 v13, v13, v29
    v_add_f32 v45, v45, v61
    v_add_f32 v14, v14, v30
    v_add_f32 v46, v46, v62
    v_add_f32 v15, v15, v31
    v_add_f32 v47, v47, v63
    v_add_f32 v0, v0, v32
    v_add_f32 v1, v1, v33
    v_add_f32 v2, v2, v34
    v_add_f32 v3, v3, v35
    v_add_f32 v4, v4, v36
    v_add_f32 v5, v5, v37
    v_add_f32 v6, v6, v38
    v_add_f32 v7, v7, v39
    v_add_f32 v8, v8, v40
    v_add_f32 v9, v9, v41
    v_add_f32 v10, v10, v42
    v_add_f32 v11, v11, v43
    v_add_f32 v12, v12, v44
    v_add_f32 v13, v13, v45
    v_add_f32 v14, v14, v46
    v_add_f32 v15, v15, v47
    v_cvt_pk_bf16_f32 v64, v0, v1
    v_cvt_pk_bf16_f32 v65, v2, v3
    v_cvt_pk_bf16_f32 v66, v4, v5
    v_cvt_pk_bf16_f32 v67, v6, v7
    v_cvt_pk_bf16_f32 v68, v8, v9
    v_cvt_pk_bf16_f32 v69, v10, v11
    v_cvt_pk_bf16_f32 v70, v12, v13
    v_cvt_pk_bf16_f32 v71, v14, v15
    s_lshl_b32 s28, s10, 16
    s_lshl_b32 s29, s11, 7
    s_add_u32 s28, s28, s29
    v_lshlrev_b32 v206, 10, v206
    v_lshl_add_u32 v206, v207, 5, v206
    buffer_store_dwordx4 v[64:67], v206, s[24:27], s28 offen
    buffer_store_dwordx4 v[68:71], v206, s[24:27], s28 offen offset:16
S2_exit:
    s_endpgm
.section .rodata,"a"
.p2align 6
.amdhsa_kernel gated_mix__spectral_fnet__glu_gated_glu__prompt_kernel
  .amdhsa_next_free_vgpr 256
  .amdhsa_next_free_sgpr 100
  .amdhsa_accum_offset 256
  .amdhsa_group_segment_fixed_size 0
  .amdhsa_kernarg_size 104
  .amdhsa_user_sgpr_count 2
  .amdhsa_user_sgpr_kernarg_segment_ptr 1
  .amdhsa_system_sgpr_workgroup_id_x 1
.end_amdhsa_kernel
.p2align 6
.amdhsa_kernel gmix_stage2_kernel
  .amdhsa_next_free_vgpr 384
  .amdhsa_next_free_sgpr 96
  .amdhsa_accum_offset 256
  .amdhsa_group_segment_fixed_size 0
  .amdhsa_kernarg_size 104
  .amdhsa_user_sgpr_count 2
  .amdhsa_user_sgpr_kernarg_segment_ptr 1
  .amdhsa_system_sgpr_workgroup_id_x 1
.end_amdhsa_kernel
```
